```python
import torch

def _softmax(x, axis=-1):
    return torch.softmax(x, dim=axis)
def _gelu(x):
    return torch.nn.functional.gelu(x, approximate="tanh")
def _silu(x):
    return torch.nn.functional.silu(x)
def _sigmoid(x):
    return torch.sigmoid(x)
def _layernorm(x, axis=-1, eps=1e-5):
    m = x.mean(dim=axis, keepdim=True)
    v = x.var(dim=axis, keepdim=True, unbiased=False)
    return (x - m) / torch.sqrt(v + eps)
def _scatter_add(tgt, idx, src, axis=0):
    return tgt.clone().index_add_(axis, idx, src)
def _segment_sum(src, seg, n):
    out = torch.zeros((n,) + src.shape[1:], dtype=src.dtype)
    return out.index_add_(0, seg, src)
def _pad(x, pw):
    flat = tuple(v for pair in reversed(pw) for v in pair)
    return torch.nn.functional.pad(x, flat)

kernel_name = 'sequential_preLN__gqa_block_cached__glu_gated_geglu__decode'

def setup_inputs():

    _w = (lambda a: (lambda t: t.to(torch.bfloat16) if t.is_floating_point() else t)(torch.as_tensor(a)))
    def _A_setup():
        B, Sq, D = 1, 1, 512
        Hq, Hkv, Sk, Dh = 32, 8, 65536, 128
        assert Hq % Hkv == 0, (Hq, Hkv)
        return {
            "x": _w((lambda *s: torch.randn(*s, dtype=torch.bfloat16) * 0.05)(B, Sq, D)),
            "k_cache": _w((lambda *s: torch.randn(*s, dtype=torch.bfloat16) * 1.6)(B, Hkv, Sk, Dh)),
            "v_cache": _w((lambda *s: torch.randn(*s, dtype=torch.bfloat16) * 1.6)(B, Hkv, Sk, Dh)),
            "wq": _w((lambda *s: torch.randn(*s, dtype=torch.bfloat16) * 1.6)(D, Hq * Dh) * (D ** -0.5)),
            "wo": _w((lambda *s: torch.randn(*s, dtype=torch.bfloat16) * 1.6)(Hq * Dh, D) * ((Hq * Dh) ** -0.5)),
        }
    _A_in = _A_setup()

    def _B_setup():
        B, S, Dm, Df = 1, 1, 512, 1792
        return {
            "x": _w((lambda *s: torch.randn(*s, dtype=torch.bfloat16) * 0.05)(B, S, Dm)),
            "w_gate": _w((lambda *s: torch.randn(*s, dtype=torch.bfloat16) * 0.8)(Dm, Df) * (Dm ** -0.5)),
            "w_up": _w((lambda *s: torch.randn(*s, dtype=torch.bfloat16) * 0.8)(Dm, Df) * (Dm ** -0.5)),
            "w_down": _w((lambda *s: torch.randn(*s, dtype=torch.bfloat16) * 0.8)(Df, Dm) * (Df ** -0.5)),
        }
    _B_in = _B_setup()

    return {
        "A_x": _A_in["x"],
        "A_k_cache": _A_in["k_cache"],
        "A_v_cache": _A_in["v_cache"],
        "A_wq": _A_in["wq"],
        "A_wo": _A_in["wo"],
        "B_x": _B_in["x"],
        "B_w_gate": _B_in["w_gate"],
        "B_w_up": _B_in["w_up"],
        "B_w_down": _B_in["w_down"],
    }

def reference(A_x, A_k_cache, A_v_cache, A_wq, A_wo, B_x, B_w_gate, B_w_up, B_w_down):
    def _A_ref(x, k_cache, v_cache, wq, wo):
        B, Sq, D = x.shape
        Hq, Dh = 32, 128
        Hkv = k_cache.shape[1]
        rep = Hq // Hkv
        q = (lambda x, *d: x.permute(*d))((x @ wq).reshape(B, Sq, Hq, Dh), 0, 2, 1, 3)
        k = (lambda x, n, axis: torch.repeat_interleave(x, n, dim=axis))(k_cache, rep, axis=1)
        v = (lambda x, n, axis: torch.repeat_interleave(x, n, dim=axis))(v_cache, rep, axis=1)
        scores = torch.einsum("bhqd,bhkd->bhqk", q, k) * (Dh ** -0.5)
        p = _softmax(scores, axis=-1)
        o = torch.einsum("bhqk,bhkd->bhqd", p, v)
        return (lambda x, *d: x.permute(*d))(o, 0, 2, 1, 3).reshape(B, Sq, Hq * Dh) @ wo

    def _B_ref(x, w_gate, w_up, w_down):
        g = torch.einsum("bsd,df->bsf", x, w_gate)
        u = torch.einsum("bsd,df->bsf", x, w_up)
        h = _gelu(g) * u
        return torch.einsum("bsf,fd->bsd", h, w_down)

    x = A_x
    h = x + _A_ref(_layernorm(x, axis=-1), A_k_cache, A_v_cache, A_wq, A_wo)
    h2 = h + _B_ref(_layernorm(h, axis=-1), B_w_gate, B_w_up, B_w_down)
    return h2
```

```asm
; @launch grid=(256,1,1) block=(256,1,1) lds=14592
.amdgcn_target "amdgcn-amd-amdhsa--gfx950"
.text
.globl sequential_preLN__gqa_block_cached__glu_gated_geglu__decode_kernel
.p2align 8
.type sequential_preLN__gqa_block_cached__glu_gated_geglu__decode_kernel,@function
sequential_preLN__gqa_block_cached__glu_gated_geglu__decode_kernel:
L_start:
    s_cmp_ge_u32 s2, 256
    s_cbranch_scc1 L_end
    s_load_dwordx16 s[36:51], s[0:1], 0
    s_load_dwordx8 s[52:59], s[0:1], 64
    s_getpc_b64 s[28:29]
L_pc:
    s_and_b32 s28, s28, 0xffffff00
    v_lshlrev_b32 v56, 7, v0
    v_min_u32 v56, 0x4ae4, v56
    global_load_dword v79, v56, s[28:29]
    v_lshrrev_b32 v56, 6, v0
    v_mov_b32 v1, v0
    v_readfirstlane_b32 s3, v56
    v_and_b32 v0, 63, v0
    s_mov_b64 s[90:91], -1
    v_bfe_u32 v56, v0, 2, 2
    v_lshlrev_b32 v2, 8, v56
    v_lshrrev_b32 v57, 4, v0
    v_lshl_add_u32 v2, v57, 6, v2
    v_and_b32 v58, 3, v0
    v_lshl_add_u32 v2, v58, 4, v2
    v_lshlrev_b32 v3, 4, v0
    v_lshrrev_b32 v61, 3, v0
    v_and_b32 v62, 7, v0
    v_lshlrev_b32 v63, 17, v61
    v_lshl_add_u32 v63, v62, 4, v63
    s_lshr_b32 s4, s2, 3
    s_and_b32 s4, s4, 7
    s_lshr_b32 s5, s2, 6
    s_lshl_b32 s5, s5, 3
    s_and_b32 s28, s2, 7
    s_add_u32 s5, s5, s28
    s_lshl_b32 s60, s4, 24
    s_mov_b32 s63, s60
    s_lshl_b32 s28, s5, 2
    s_add_u32 s28, s28, s3
    s_lshl_b32 s28, s28, 12
    s_add_u32 s60, s60, s28
    s_mov_b32 s61, 524288
    s_mov_b32 s68, 0xfff
    s_and_b32 s34, s2, 3
    s_lshl_b32 s34, s34, 7
    s_lshl_b32 s30, s34, 13
    s_lshr_b32 s31, s2, 2
    s_lshl_b32 s31, s31, 7
    s_add_u32 s30, s30, s31
    s_waitcnt lgkmcnt(0)
    s_mov_b32 s8, s38
    s_and_b32 s9, s39, 0xffff
    s_mov_b32 s10, 0x8000000
    s_mov_b32 s11, 0x20000
    s_mov_b32 s12, s40
    s_and_b32 s13, s41, 0xffff
    s_mov_b32 s14, 0x8000000
    s_mov_b32 s15, 0x20000
    s_mov_b32 s16, s58
    s_and_b32 s17, s59, 0xffff
    s_mov_b32 s18, 0x200000
    s_mov_b32 s19, 0x20000
    s_mov_b32 s20, s36
    s_and_b32 s21, s37, 0xffff
    s_mov_b32 s22, 0x400
    s_mov_b32 s23, 0x20000
    s_mov_b32 s24, s42
    s_and_b32 s25, s43, 0xffff
    s_mov_b32 s26, 0x400000
    s_mov_b32 s27, 0x20000
    s_cmp_eq_u32 s3, 0
    s_cbranch_scc0 L_gate
    s_and_b32 s28, s2, 31
    s_cmp_eq_u32 s28, 0
    s_cbranch_scc0 L_noinit
    s_lshr_b32 s28, s2, 5
    s_lshl_b32 s28, s28, 10
    s_add_u32 s28, s28, 4096
    v_lshlrev_b32 v58, 8, v0
    v_add_u32 v58, s28, v58
    v_mov_b32 v57, 0
    s_mov_b64 exec, 15
    buffer_atomic_swap v57, v58, s[16:19], 0 offen sc0
    s_mov_b64 exec, -1
L_noinit:
    buffer_load_dwordx4 v[72:75], v3, s[20:23], 0 offen
    buffer_load_dwordx4 v[80:83], v63, s[24:27], s30 offen
    s_add_u32 s30, s30, 8192
    buffer_load_dwordx4 v[84:87], v63, s[24:27], s30 offen
    s_add_u32 s30, s30, 8192
    buffer_load_dwordx4 v[88:91], v63, s[24:27], s30 offen
    s_add_u32 s30, s30, 8192
    buffer_load_dwordx4 v[92:95], v63, s[24:27], s30 offen
    s_add_u32 s30, s30, 8192
    buffer_load_dwordx4 v[96:99], v63, s[24:27], s30 offen
    s_add_u32 s30, s30, 8192
    buffer_load_dwordx4 v[100:103], v63, s[24:27], s30 offen
    s_add_u32 s30, s30, 8192
    buffer_load_dwordx4 v[104:107], v63, s[24:27], s30 offen
    s_add_u32 s30, s30, 8192
    buffer_load_dwordx4 v[108:111], v63, s[24:27], s30 offen
    s_add_u32 s30, s30, 8192
    buffer_load_dwordx4 v[112:115], v63, s[24:27], s30 offen
    s_add_u32 s30, s30, 8192
    buffer_load_dwordx4 v[116:119], v63, s[24:27], s30 offen
    s_add_u32 s30, s30, 8192
    buffer_load_dwordx4 v[120:123], v63, s[24:27], s30 offen
    s_add_u32 s30, s30, 8192
    buffer_load_dwordx4 v[124:127], v63, s[24:27], s30 offen
    s_add_u32 s30, s30, 8192
    buffer_load_dwordx4 v[128:131], v63, s[24:27], s30 offen
    s_add_u32 s30, s30, 8192
    buffer_load_dwordx4 v[132:135], v63, s[24:27], s30 offen
    s_add_u32 s30, s30, 8192
    buffer_load_dwordx4 v[136:139], v63, s[24:27], s30 offen
    s_add_u32 s30, s30, 8192
    buffer_load_dwordx4 v[140:143], v63, s[24:27], s30 offen
    s_load_dword s7, s[58:59], 0
L_gate:
    s_barrier
    s_cmp_eq_u32 s3, 0
    s_cbranch_scc1 L_w0
    buffer_load_dwordx4 a[0:3], v2, s[8:11], s60 offen offset:0 nt
    buffer_load_dwordx4 a[4:7], v2, s[8:11], s60 offen offset:1024 nt
    buffer_load_dwordx4 a[8:11], v2, s[8:11], s60 offen offset:2048 nt
    buffer_load_dwordx4 a[12:15], v2, s[8:11], s60 offen offset:3072 nt
    buffer_load_dwordx4 a[16:19], v3, s[12:15], s60 offen offset:0 nt
    buffer_load_dwordx4 a[20:23], v3, s[12:15], s60 offen offset:1024 nt
    buffer_load_dwordx4 a[24:27], v3, s[12:15], s60 offen offset:2048 nt
    buffer_load_dwordx4 a[28:31], v3, s[12:15], s60 offen offset:3072 nt
    s_add_u32 s60, s60, s61
    s_mov_b32 s65, 0
    s_cmp_lt_u32 s2, 64
    s_cselect_b32 s65, 1, s65
    s_sub_u32 s28, s2, 64
    s_and_b32 s29, s28, 7
    s_lshr_b32 s30, s28, 4
    s_lshl_b32 s30, s30, 3
    s_add_u32 s29, s29, s30
    s_lshl_b32 s29, s29, 1
    s_lshr_b32 s30, s28, 3
    s_and_b32 s30, s30, 1
    s_add_u32 s69, s29, s30
    s_cmp_lt_u32 s28, 64
    s_cselect_b32 s30, 1, 0
    s_cmp_lt_u32 s69, 56
    s_cselect_b32 s31, s30, 0
    s_cmp_eq_u32 s31, 1
    s_cselect_b32 s65, 2, s65
    s_sub_u32 s28, s2, 128
    s_cmp_lt_u32 s28, 32
    s_cselect_b32 s65, 3, s65
    s_cmp_eq_u32 s65, 1
    s_cbranch_scc0 L_w_notwo_1
    s_mov_b32 s20, s44
    s_and_b32 s21, s45, 0xffff
    s_mov_b32 s22, 0x400000
    s_mov_b32 s23, 0x20000
    v_lshrrev_b32 v56, 2, v0
    v_lshlrev_b32 v56, 14, v56
    v_and_b32 v57, 3, v0
    v_lshl_add_u32 v56, v57, 4, v56
    s_lshr_b32 s28, s2, 5
    s_lshl_b32 s28, s28, 3
    s_and_b32 s29, s2, 7
    s_add_u32 s28, s28, s29
    s_lshr_b32 s29, s2, 3
    s_and_b32 s29, s29, 3
    s_lshl_b32 s28, s28, 18
    s_lshl_b32 s29, s29, 8
    s_add_u32 s28, s28, s29
    s_lshl_b32 s29, s3, 6
    s_add_u32 s28, s28, s29
    buffer_load_dwordx4 v[80:83], v56, s[20:23], s28 offen offset:0
    buffer_load_dwordx4 v[84:87], v56, s[20:23], s28 offen offset:1024
    buffer_load_dwordx4 v[88:91], v56, s[20:23], s28 offen offset:2048
    buffer_load_dwordx4 v[92:95], v56, s[20:23], s28 offen offset:3072
    s_add_u32 s28, s28, 4096
    buffer_load_dwordx4 v[96:99], v56, s[20:23], s28 offen offset:0
    buffer_load_dwordx4 v[100:103], v56, s[20:23], s28 offen offset:1024
    buffer_load_dwordx4 v[104:107], v56, s[20:23], s28 offen offset:2048
    buffer_load_dwordx4 v[108:111], v56, s[20:23], s28 offen offset:3072
    s_add_u32 s28, s28, 4096
    buffer_load_dwordx4 v[112:115], v56, s[20:23], s28 offen offset:0
    buffer_load_dwordx4 v[116:119], v56, s[20:23], s28 offen offset:1024
    buffer_load_dwordx4 v[120:123], v56, s[20:23], s28 offen offset:2048
    buffer_load_dwordx4 v[124:127], v56, s[20:23], s28 offen offset:3072
    s_add_u32 s28, s28, 4096
    buffer_load_dwordx4 v[128:131], v56, s[20:23], s28 offen offset:0
    buffer_load_dwordx4 v[132:135], v56, s[20:23], s28 offen offset:1024
    buffer_load_dwordx4 v[136:139], v56, s[20:23], s28 offen offset:2048
    buffer_load_dwordx4 v[140:143], v56, s[20:23], s28 offen offset:3072
    s_branch L_w_done_1
L_w_notwo_1:
    s_cmp_eq_u32 s65, 2
    s_cbranch_scc0 L_w_done_1
    s_mov_b32 s20, s48
    s_and_b32 s21, s49, 0xffff
    s_mov_b32 s22, 0x1c0000
    s_mov_b32 s23, 0x20000
    s_mov_b32 s24, s50
    s_and_b32 s25, s51, 0xffff
    s_mov_b32 s26, 0x1c0000
    s_mov_b32 s27, 0x20000
    v_lshrrev_b32 v56, 2, v0
    v_mul_u32_u24 v56, 28672, v56
    v_and_b32 v57, 3, v0
    v_lshl_add_u32 v56, v57, 4, v56
    s_mul_i32 s28, s3, 458752
    s_lshl_b32 s29, s69, 6
    s_add_u32 s28, s28, s29
    buffer_load_dwordx4 v[80:83], v56, s[20:23], s28 offen
    buffer_load_dwordx4 v[112:115], v56, s[24:27], s28 offen
    s_add_u32 s28, s28, 3584
    buffer_load_dwordx4 v[84:87], v56, s[20:23], s28 offen
    buffer_load_dwordx4 v[116:119], v56, s[24:27], s28 offen
    s_add_u32 s28, s28, 3584
    buffer_load_dwordx4 v[88:91], v56, s[20:23], s28 offen
    buffer_load_dwordx4 v[120:123], v56, s[24:27], s28 offen
    s_add_u32 s28, s28, 3584
    buffer_load_dwordx4 v[92:95], v56, s[20:23], s28 offen
    buffer_load_dwordx4 v[124:127], v56, s[24:27], s28 offen
    s_add_u32 s28, s28, 3584
    buffer_load_dwordx4 v[96:99], v56, s[20:23], s28 offen
    buffer_load_dwordx4 v[128:131], v56, s[24:27], s28 offen
    s_add_u32 s28, s28, 3584
    buffer_load_dwordx4 v[100:103], v56, s[20:23], s28 offen
    buffer_load_dwordx4 v[132:135], v56, s[24:27], s28 offen
    s_add_u32 s28, s28, 3584
    buffer_load_dwordx4 v[104:107], v56, s[20:23], s28 offen
    buffer_load_dwordx4 v[136:139], v56, s[24:27], s28 offen
    s_add_u32 s28, s28, 3584
    buffer_load_dwordx4 v[108:111], v56, s[20:23], s28 offen
    buffer_load_dwordx4 v[140:143], v56, s[24:27], s28 offen
    s_mov_b32 s20, s52
    s_and_b32 s21, s53, 0xffff
    s_mov_b32 s22, 0x1c0000
    s_mov_b32 s23, 0x20000
    v_lshrrev_b32 v56, 4, v0
    v_lshlrev_b32 v56, 13, v56
    v_and_b32 v57, 15, v0
    v_lshl_add_u32 v56, v57, 4, v56
    s_lshl_b32 s28, s69, 15
    s_lshl_b32 s29, s3, 8
    s_add_u32 s28, s28, s29
    buffer_load_dwordx4 v[144:147], v56, s[20:23], s28 offen offset:0
    buffer_load_dwordx4 v[148:151], v56, s[20:23], s28 offen offset:1024
    buffer_load_dwordx4 v[152:155], v56, s[20:23], s28 offen offset:2048
    buffer_load_dwordx4 v[156:159], v56, s[20:23], s28 offen offset:3072
    s_add_u32 s28, s28, 4096
    buffer_load_dwordx4 v[160:163], v56, s[20:23], s28 offen offset:0
    buffer_load_dwordx4 v[164:167], v56, s[20:23], s28 offen offset:1024
    buffer_load_dwordx4 v[168:171], v56, s[20:23], s28 offen offset:2048
    buffer_load_dwordx4 v[172:175], v56, s[20:23], s28 offen offset:3072
L_w_done_1:
    s_waitcnt vmcnt(4)
    buffer_load_dwordx4 a[32:35], v2, s[8:11], s60 offen offset:0 nt
    buffer_load_dwordx4 a[36:39], v2, s[8:11], s60 offen offset:1024 nt
    buffer_load_dwordx4 a[40:43], v2, s[8:11], s60 offen offset:2048 nt
    buffer_load_dwordx4 a[44:47], v2, s[8:11], s60 offen offset:3072 nt
    s_waitcnt vmcnt(4)
    buffer_load_dwordx4 a[48:51], v3, s[12:15], s60 offen offset:0 nt
    buffer_load_dwordx4 a[52:55], v3, s[12:15], s60 offen offset:1024 nt
    buffer_load_dwordx4 a[56:59], v3, s[12:15], s60 offen offset:2048 nt
    buffer_load_dwordx4 a[60:63], v3, s[12:15], s60 offen offset:3072 nt
    s_add_u32 s60, s60, s61
    s_waitcnt vmcnt(4)
    buffer_load_dwordx4 a[64:67], v2, s[8:11], s60 offen offset:0 nt
    buffer_load_dwordx4 a[68:71], v2, s[8:11], s60 offen offset:1024 nt
    buffer_load_dwordx4 a[72:75], v2, s[8:11], s60 offen offset:2048 nt
    buffer_load_dwordx4 a[76:79], v2, s[8:11], s60 offen offset:3072 nt
    s_waitcnt vmcnt(4)
    buffer_load_dwordx4 a[80:83], v3, s[12:15], s60 offen offset:0 nt
    buffer_load_dwordx4 a[84:87], v3, s[12:15], s60 offen offset:1024 nt
    buffer_load_dwordx4 a[88:91], v3, s[12:15], s60 offen offset:2048 nt
    buffer_load_dwordx4 a[92:95], v3, s[12:15], s60 offen offset:3072 nt
    s_add_u32 s60, s60, s61
    s_waitcnt vmcnt(4)
    buffer_load_dwordx4 a[96:99], v2, s[8:11], s60 offen offset:0 nt
    buffer_load_dwordx4 a[100:103], v2, s[8:11], s60 offen offset:1024 nt
    buffer_load_dwordx4 a[104:107], v2, s[8:11], s60 offen offset:2048 nt
    buffer_load_dwordx4 a[108:111], v2, s[8:11], s60 offen offset:3072 nt
    s_waitcnt vmcnt(4)
    buffer_load_dwordx4 a[112:115], v3, s[12:15], s60 offen offset:0 nt
    buffer_load_dwordx4 a[116:119], v3, s[12:15], s60 offen offset:1024 nt
    buffer_load_dwordx4 a[120:123], v3, s[12:15], s60 offen offset:2048 nt
    buffer_load_dwordx4 a[124:127], v3, s[12:15], s60 offen offset:3072 nt
    s_add_u32 s60, s60, s61
    s_waitcnt vmcnt(4)
    buffer_load_dwordx4 a[128:131], v2, s[8:11], s60 offen offset:0 nt
    buffer_load_dwordx4 a[132:135], v2, s[8:11], s60 offen offset:1024 nt
    buffer_load_dwordx4 a[136:139], v2, s[8:11], s60 offen offset:2048 nt
    buffer_load_dwordx4 a[140:143], v2, s[8:11], s60 offen offset:3072 nt
    s_waitcnt vmcnt(4)
    buffer_load_dwordx4 a[144:147], v3, s[12:15], s60 offen offset:0 nt
    buffer_load_dwordx4 a[148:151], v3, s[12:15], s60 offen offset:1024 nt
    buffer_load_dwordx4 a[152:155], v3, s[12:15], s60 offen offset:2048 nt
    buffer_load_dwordx4 a[156:159], v3, s[12:15], s60 offen offset:3072 nt
    s_add_u32 s60, s60, s61
    s_waitcnt vmcnt(4)
    buffer_load_dwordx4 a[160:163], v2, s[8:11], s60 offen offset:0 nt
    buffer_load_dwordx4 a[164:167], v2, s[8:11], s60 offen offset:1024 nt
    buffer_load_dwordx4 a[168:171], v2, s[8:11], s60 offen offset:2048 nt
    buffer_load_dwordx4 a[172:175], v2, s[8:11], s60 offen offset:3072 nt
    s_waitcnt vmcnt(4)
    buffer_load_dwordx4 a[176:179], v3, s[12:15], s60 offen offset:0 nt
    buffer_load_dwordx4 a[180:183], v3, s[12:15], s60 offen offset:1024 nt
    buffer_load_dwordx4 a[184:187], v3, s[12:15], s60 offen offset:2048 nt
    buffer_load_dwordx4 a[188:191], v3, s[12:15], s60 offen offset:3072 nt
    s_add_u32 s60, s60, s61
    s_branch L_common
L_w0:
    s_waitcnt vmcnt(16)
    v_lshlrev_b32 v24, 16, v72
    v_and_b32 v25, 0xffff0000, v72
    v_lshlrev_b32 v26, 16, v73
    v_and_b32 v27, 0xffff0000, v73
    v_lshlrev_b32 v28, 16, v74
    v_and_b32 v29, 0xffff0000, v74
    v_lshlrev_b32 v30, 16, v75
    v_and_b32 v31, 0xffff0000, v75
    v_add_f32 v56, v24, v25
    v_add_f32 v56, v56, v26
    v_add_f32 v56, v56, v27
    v_add_f32 v56, v56, v28
    v_add_f32 v56, v56, v29
    v_add_f32 v56, v56, v30
    v_add_f32 v56, v56, v31
    s_nop 1
    v_add_f32_dpp v56, v56, v56 row_ror:1 row_mask:0xf bank_mask:0xf
    s_nop 1
    v_add_f32_dpp v56, v56, v56 row_ror:2 row_mask:0xf bank_mask:0xf
    s_nop 1
    v_add_f32_dpp v56, v56, v56 row_ror:4 row_mask:0xf bank_mask:0xf
    s_nop 1
    v_add_f32_dpp v56, v56, v56 row_ror:8 row_mask:0xf bank_mask:0xf
    v_mov_b32 v57, v56
    s_nop 1
    v_permlane16_swap_b32 v57, v56
    v_add_f32 v56, v56, v57
    v_mov_b32 v57, v56
    s_nop 1
    v_permlane32_swap_b32 v57, v56
    v_add_f32 v56, v56, v57
    v_mul_f32 v56, 0x3b000000, v56
    v_sub_f32 v32, v24, v56
    v_sub_f32 v33, v25, v56
    v_sub_f32 v34, v26, v56
    v_sub_f32 v35, v27, v56
    v_sub_f32 v36, v28, v56
    v_sub_f32 v37, v29, v56
    v_sub_f32 v38, v30, v56
    v_sub_f32 v39, v31, v56
    v_mul_f32 v57, v32, v32
    v_fma_f32 v57, v33, v33, v57
    v_fma_f32 v57, v34, v34, v57
    v_fma_f32 v57, v35, v35, v57
    v_fma_f32 v57, v36, v36, v57
    v_fma_f32 v57, v37, v37, v57
    v_fma_f32 v57, v38, v38, v57
    v_fma_f32 v57, v39, v39, v57
    s_nop 1
    v_add_f32_dpp v57, v57, v57 row_ror:1 row_mask:0xf bank_mask:0xf
    s_nop 1
    v_add_f32_dpp v57, v57, v57 row_ror:2 row_mask:0xf bank_mask:0xf
    s_nop 1
    v_add_f32_dpp v57, v57, v57 row_ror:4 row_mask:0xf bank_mask:0xf
    s_nop 1
    v_add_f32_dpp v57, v57, v57 row_ror:8 row_mask:0xf bank_mask:0xf
    v_mov_b32 v58, v57
    s_nop 1
    v_permlane16_swap_b32 v58, v57
    v_add_f32 v57, v57, v58
    v_mov_b32 v58, v57
    s_nop 1
    v_permlane32_swap_b32 v58, v57
    v_add_f32 v57, v57, v58
    v_mul_f32 v57, 0x3b000000, v57
    v_cvt_pk_bf16_f32 v56, v56, v56
    v_and_b32 v56, 0xffff0000, v56
    v_cvt_pk_bf16_f32 v57, v57, v57
    v_and_b32 v57, 0xffff0000, v57
    v_add_f32 v57, 0x3727c5ac, v57
    v_cvt_pk_bf16_f32 v57, v57, v57
    v_and_b32 v57, 0xffff0000, v57
    v_sqrt_f32 v57, v57
    s_nop 0
    v_cvt_pk_bf16_f32 v57, v57, v57
    v_and_b32 v57, 0xffff0000, v57
    v_rcp_f32 v58, v57
    v_sub_f32 v24, v24, v56
    v_sub_f32 v25, v25, v56
    v_sub_f32 v26, v26, v56
    v_sub_f32 v27, v27, v56
    v_sub_f32 v28, v28, v56
    v_sub_f32 v29, v29, v56
    v_sub_f32 v30, v30, v56
    v_sub_f32 v31, v31, v56
    v_cvt_pk_bf16_f32 v59, v24, v25
    v_lshlrev_b32 v24, 16, v59
    v_and_b32 v25, 0xffff0000, v59
    v_cvt_pk_bf16_f32 v59, v26, v27
    v_lshlrev_b32 v26, 16, v59
    v_and_b32 v27, 0xffff0000, v59
    v_cvt_pk_bf16_f32 v59, v28, v29
    v_lshlrev_b32 v28, 16, v59
    v_and_b32 v29, 0xffff0000, v59
    v_cvt_pk_bf16_f32 v59, v30, v31
    v_lshlrev_b32 v30, 16, v59
    v_and_b32 v31, 0xffff0000, v59
    v_mul_f32 v32, v24, v58
    v_fma_f32 v24, -v32, v57, v24
    v_fma_f32 v32, v24, v58, v32
    v_mul_f32 v33, v25, v58
    v_fma_f32 v25, -v33, v57, v25
    v_fma_f32 v33, v25, v58, v33
    v_mul_f32 v34, v26, v58
    v_fma_f32 v26, -v34, v57, v26
    v_fma_f32 v34, v26, v58, v34
    v_mul_f32 v35, v27, v58
    v_fma_f32 v27, -v35, v57, v27
    v_fma_f32 v35, v27, v58, v35
    v_mul_f32 v36, v28, v58
    v_fma_f32 v28, -v36, v57, v28
    v_fma_f32 v36, v28, v58, v36
    v_mul_f32 v37, v29, v58
    v_fma_f32 v29, -v37, v57, v29
    v_fma_f32 v37, v29, v58, v37
    v_mul_f32 v38, v30, v58
    v_fma_f32 v30, -v38, v57, v30
    v_fma_f32 v38, v30, v58, v38
    v_mul_f32 v39, v31, v58
    v_fma_f32 v31, -v39, v57, v31
    v_fma_f32 v39, v31, v58, v39
    v_cvt_pk_bf16_f32 v24, v32, v33
    v_cvt_pk_bf16_f32 v25, v34, v35
    v_cvt_pk_bf16_f32 v26, v36, v37
    v_cvt_pk_bf16_f32 v27, v38, v39
    ds_write_b128 v3, v[24:27] offset:0
    v_lshlrev_b32 v59, 5, v61
    s_lshl_b32 s29, s34, 1
    v_add_u32 v59, s29, v59
    s_waitcnt lgkmcnt(0)
    ds_read_b128 v[40:43], v59 offset:0
    ds_read_b128 v[44:47], v59 offset:16
    s_add_u32 s7, s7, 1
    s_and_b32 s6, s7, 0xfff
    v_mov_b32 v23, s6
    v_mov_b32 v177, s7
    s_mov_b32 s28, 0x05040100
    s_mov_b32 s29, 0x07060302
    v_mov_b32 v24, 0
    v_mov_b32 v25, 0
    v_mov_b32 v26, 0
    v_mov_b32 v27, 0
    v_mov_b32 v28, 0
    v_mov_b32 v29, 0
    v_mov_b32 v30, 0
    v_mov_b32 v31, 0
    s_waitcnt vmcnt(0) lgkmcnt(0)
    v_perm_b32 v56, v84, v80, s28
    v_perm_b32 v57, v84, v80, s29
    v_dot2c_f32_bf16 v24, v56, v40
    v_dot2c_f32_bf16 v25, v57, v40
    v_perm_b32 v56, v85, v81, s28
    v_perm_b32 v57, v85, v81, s29
    v_dot2c_f32_bf16 v26, v56, v40
    v_dot2c_f32_bf16 v27, v57, v40
    v_perm_b32 v56, v86, v82, s28
    v_perm_b32 v57, v86, v82, s29
    v_dot2c_f32_bf16 v28, v56, v40
    v_dot2c_f32_bf16 v29, v57, v40
    v_perm_b32 v56, v87, v83, s28
    v_perm_b32 v57, v87, v83, s29
    v_dot2c_f32_bf16 v30, v56, v40
    v_dot2c_f32_bf16 v31, v57, v40
    v_perm_b32 v56, v92, v88, s28
    v_perm_b32 v57, v92, v88, s29
    v_dot2c_f32_bf16 v24, v56, v41
    v_dot2c_f32_bf16 v25, v57, v41
    v_perm_b32 v56, v93, v89, s28
    v_perm_b32 v57, v93, v89, s29
    v_dot2c_f32_bf16 v26, v56, v41
    v_dot2c_f32_bf16 v27, v57, v41
    v_perm_b32 v56, v94, v90, s28
    v_perm_b32 v57, v94, v90, s29
    v_dot2c_f32_bf16 v28, v56, v41
    v_dot2c_f32_bf16 v29, v57, v41
    v_perm_b32 v56, v95, v91, s28
    v_perm_b32 v57, v95, v91, s29
    v_dot2c_f32_bf16 v30, v56, v41
    v_dot2c_f32_bf16 v31, v57, v41
    v_perm_b32 v56, v100, v96, s28
    v_perm_b32 v57, v100, v96, s29
    v_dot2c_f32_bf16 v24, v56, v42
    v_dot2c_f32_bf16 v25, v57, v42
    v_perm_b32 v56, v101, v97, s28
    v_perm_b32 v57, v101, v97, s29
    v_dot2c_f32_bf16 v26, v56, v42
    v_dot2c_f32_bf16 v27, v57, v42
    v_perm_b32 v56, v102, v98, s28
    v_perm_b32 v57, v102, v98, s29
    v_dot2c_f32_bf16 v28, v56, v42
    v_dot2c_f32_bf16 v29, v57, v42
    v_perm_b32 v56, v103, v99, s28
    v_perm_b32 v57, v103, v99, s29
    v_dot2c_f32_bf16 v30, v56, v42
    v_dot2c_f32_bf16 v31, v57, v42
    v_perm_b32 v56, v108, v104, s28
    v_perm_b32 v57, v108, v104, s29
    v_dot2c_f32_bf16 v24, v56, v43
    v_dot2c_f32_bf16 v25, v57, v43
    v_perm_b32 v56, v109, v105, s28
    v_perm_b32 v57, v109, v105, s29
    v_dot2c_f32_bf16 v26, v56, v43
    v_dot2c_f32_bf16 v27, v57, v43
    v_perm_b32 v56, v110, v106, s28
    v_perm_b32 v57, v110, v106, s29
    v_dot2c_f32_bf16 v28, v56, v43
    v_dot2c_f32_bf16 v29, v57, v43
    v_perm_b32 v56, v111, v107, s28
    v_perm_b32 v57, v111, v107, s29
    v_dot2c_f32_bf16 v30, v56, v43
    v_dot2c_f32_bf16 v31, v57, v43
    v_perm_b32 v56, v116, v112, s28
    v_perm_b32 v57, v116, v112, s29
    v_dot2c_f32_bf16 v24, v56, v44
    v_dot2c_f32_bf16 v25, v57, v44
    v_perm_b32 v56, v117, v113, s28
    v_perm_b32 v57, v117, v113, s29
    v_dot2c_f32_bf16 v26, v56, v44
    v_dot2c_f32_bf16 v27, v57, v44
    v_perm_b32 v56, v118, v114, s28
    v_perm_b32 v57, v118, v114, s29
    v_dot2c_f32_bf16 v28, v56, v44
    v_dot2c_f32_bf16 v29, v57, v44
    v_perm_b32 v56, v119, v115, s28
    v_perm_b32 v57, v119, v115, s29
    v_dot2c_f32_bf16 v30, v56, v44
    v_dot2c_f32_bf16 v31, v57, v44
    v_perm_b32 v56, v124, v120, s28
    v_perm_b32 v57, v124, v120, s29
    v_dot2c_f32_bf16 v24, v56, v45
    v_dot2c_f32_bf16 v25, v57, v45
    v_perm_b32 v56, v125, v121, s28
    v_perm_b32 v57, v125, v121, s29
    v_dot2c_f32_bf16 v26, v56, v45
    v_dot2c_f32_bf16 v27, v57, v45
    v_perm_b32 v56, v126, v122, s28
    v_perm_b32 v57, v126, v122, s29
    v_dot2c_f32_bf16 v28, v56, v45
    v_dot2c_f32_bf16 v29, v57, v45
    v_perm_b32 v56, v127, v123, s28
    v_perm_b32 v57, v127, v123, s29
    v_dot2c_f32_bf16 v30, v56, v45
    v_dot2c_f32_bf16 v31, v57, v45
    v_perm_b32 v56, v132, v128, s28
    v_perm_b32 v57, v132, v128, s29
    v_dot2c_f32_bf16 v24, v56, v46
    v_dot2c_f32_bf16 v25, v57, v46
    v_perm_b32 v56, v133, v129, s28
    v_perm_b32 v57, v133, v129, s29
    v_dot2c_f32_bf16 v26, v56, v46
    v_dot2c_f32_bf16 v27, v57, v46
    v_perm_b32 v56, v134, v130, s28
    v_perm_b32 v57, v134, v130, s29
    v_dot2c_f32_bf16 v28, v56, v46
    v_dot2c_f32_bf16 v29, v57, v46
    v_perm_b32 v56, v135, v131, s28
    v_perm_b32 v57, v135, v131, s29
    v_dot2c_f32_bf16 v30, v56, v46
    v_dot2c_f32_bf16 v31, v57, v46
    v_perm_b32 v56, v140, v136, s28
    v_perm_b32 v57, v140, v136, s29
    v_dot2c_f32_bf16 v24, v56, v47
    v_dot2c_f32_bf16 v25, v57, v47
    v_perm_b32 v56, v141, v137, s28
    v_perm_b32 v57, v141, v137, s29
    v_dot2c_f32_bf16 v26, v56, v47
    v_dot2c_f32_bf16 v27, v57, v47
    v_perm_b32 v56, v142, v138, s28
    v_perm_b32 v57, v142, v138, s29
    v_dot2c_f32_bf16 v28, v56, v47
    v_dot2c_f32_bf16 v29, v57, v47
    v_perm_b32 v56, v143, v139, s28
    v_perm_b32 v57, v143, v139, s29
    v_dot2c_f32_bf16 v30, v56, v47
    v_dot2c_f32_bf16 v31, v57, v47
    v_permlane32_swap_b32 v24, v28
    v_add_f32 v24, v24, v28
    v_permlane32_swap_b32 v25, v29
    v_add_f32 v25, v25, v29
    v_permlane32_swap_b32 v26, v30
    v_add_f32 v26, v26, v30
    v_permlane32_swap_b32 v27, v31
    v_add_f32 v27, v27, v31
    v_permlane16_swap_b32 v24, v26
    v_add_f32 v24, v24, v26
    v_permlane16_swap_b32 v25, v27
    v_add_f32 v25, v25, v27
    v_add_f32_dpp v24, v24, v24 row_ror:8 row_mask:0xf bank_mask:0xf
    s_nop 0
    v_add_f32_dpp v25, v25, v25 row_ror:8 row_mask:0xf bank_mask:0xf
    v_mov_b32 v26, v25
    v_mov_b32 v25, v177
    v_mov_b32 v27, v177
    v_lshrrev_b32 v56, 4, v0
    v_lshl_add_u32 v56, v62, 2, v56
    v_lshlrev_b32 v56, 4, v56
    s_lshr_b32 s28, s2, 5
    s_lshl_b32 s28, s28, 14
    s_and_b32 s29, s2, 3
    s_lshl_b32 s29, s29, 12
    s_add_u32 s28, s28, s29
    s_lshr_b32 s29, s2, 2
    s_and_b32 s29, s29, 7
    s_lshl_b32 s29, s29, 9
    s_add_u32 s28, s28, s29
    s_add_u32 s28, s28, 65536
    s_mov_b32 exec_lo, 0x00ff00ff
    s_mov_b32 exec_hi, 0x00ff00ff
    buffer_store_dwordx4 v[24:27], v56, s[16:19], s28 offen sc1
    s_mov_b64 exec, -1
    s_mov_b32 s65, 0
    s_cmp_lt_u32 s2, 64
    s_cselect_b32 s65, 1, s65
    s_sub_u32 s28, s2, 64
    s_and_b32 s29, s28, 7
    s_lshr_b32 s30, s28, 4
    s_lshl_b32 s30, s30, 3
    s_add_u32 s29, s29, s30
    s_lshl_b32 s29, s29, 1
    s_lshr_b32 s30, s28, 3
    s_and_b32 s30, s30, 1
    s_add_u32 s69, s29, s30
    s_cmp_lt_u32 s28, 64
    s_cselect_b32 s30, 1, 0
    s_cmp_lt_u32 s69, 56
    s_cselect_b32 s31, s30, 0
    s_cmp_eq_u32 s31, 1
    s_cselect_b32 s65, 2, s65
    s_sub_u32 s28, s2, 128
    s_cmp_lt_u32 s28, 32
    s_cselect_b32 s65, 3, s65
    s_cmp_eq_u32 s65, 1
    s_cbranch_scc0 L_w_notwo_2
    s_mov_b32 s20, s44
    s_and_b32 s21, s45, 0xffff
    s_mov_b32 s22, 0x400000
    s_mov_b32 s23, 0x20000
    v_lshrrev_b32 v56, 2, v0
    v_lshlrev_b32 v56, 14, v56
    v_and_b32 v57, 3, v0
    v_lshl_add_u32 v56, v57, 4, v56
    s_lshr_b32 s28, s2, 5
    s_lshl_b32 s28, s28, 3
    s_and_b32 s29, s2, 7
    s_add_u32 s28, s28, s29
    s_lshr_b32 s29, s2, 3
    s_and_b32 s29, s29, 3
    s_lshl_b32 s28, s28, 18
    s_lshl_b32 s29, s29, 8
    s_add_u32 s28, s28, s29
    s_lshl_b32 s29, s3, 6
    s_add_u32 s28, s28, s29
    buffer_load_dwordx4 v[80:83], v56, s[20:23], s28 offen offset:0
    buffer_load_dwordx4 v[84:87], v56, s[20:23], s28 offen offset:1024
    buffer_load_dwordx4 v[88:91], v56, s[20:23], s28 offen offset:2048
    buffer_load_dwordx4 v[92:95], v56, s[20:23], s28 offen offset:3072
    s_add_u32 s28, s28, 4096
    buffer_load_dwordx4 v[96:99], v56, s[20:23], s28 offen offset:0
    buffer_load_dwordx4 v[100:103], v56, s[20:23], s28 offen offset:1024
    buffer_load_dwordx4 v[104:107], v56, s[20:23], s28 offen offset:2048
    buffer_load_dwordx4 v[108:111], v56, s[20:23], s28 offen offset:3072
    s_add_u32 s28, s28, 4096
    buffer_load_dwordx4 v[112:115], v56, s[20:23], s28 offen offset:0
    buffer_load_dwordx4 v[116:119], v56, s[20:23], s28 offen offset:1024
    buffer_load_dwordx4 v[120:123], v56, s[20:23], s28 offen offset:2048
    buffer_load_dwordx4 v[124:127], v56, s[20:23], s28 offen offset:3072
    s_add_u32 s28, s28, 4096
    buffer_load_dwordx4 v[128:131], v56, s[20:23], s28 offen offset:0
    buffer_load_dwordx4 v[132:135], v56, s[20:23], s28 offen offset:1024
    buffer_load_dwordx4 v[136:139], v56, s[20:23], s28 offen offset:2048
    buffer_load_dwordx4 v[140:143], v56, s[20:23], s28 offen offset:3072
    s_branch L_w_done_2
L_w_notwo_2:
    s_cmp_eq_u32 s65, 2
    s_cbranch_scc0 L_w_done_2
    s_mov_b32 s20, s48
    s_and_b32 s21, s49, 0xffff
    s_mov_b32 s22, 0x1c0000
    s_mov_b32 s23, 0x20000
    s_mov_b32 s24, s50
    s_and_b32 s25, s51, 0xffff
    s_mov_b32 s26, 0x1c0000
    s_mov_b32 s27, 0x20000
    v_lshrrev_b32 v56, 2, v0
    v_mul_u32_u24 v56, 28672, v56
    v_and_b32 v57, 3, v0
    v_lshl_add_u32 v56, v57, 4, v56
    s_mul_i32 s28, s3, 458752
    s_lshl_b32 s29, s69, 6
    s_add_u32 s28, s28, s29
    buffer_load_dwordx4 v[80:83], v56, s[20:23], s28 offen
    buffer_load_dwordx4 v[112:115], v56, s[24:27], s28 offen
    s_add_u32 s28, s28, 3584
    buffer_load_dwordx4 v[84:87], v56, s[20:23], s28 offen
    buffer_load_dwordx4 v[116:119], v56, s[24:27], s28 offen
    s_add_u32 s28, s28, 3584
    buffer_load_dwordx4 v[88:91], v56, s[20:23], s28 offen
    buffer_load_dwordx4 v[120:123], v56, s[24:27], s28 offen
    s_add_u32 s28, s28, 3584
    buffer_load_dwordx4 v[92:95], v56, s[20:23], s28 offen
    buffer_load_dwordx4 v[124:127], v56, s[24:27], s28 offen
    s_add_u32 s28, s28, 3584
    buffer_load_dwordx4 v[96:99], v56, s[20:23], s28 offen
    buffer_load_dwordx4 v[128:131], v56, s[24:27], s28 offen
    s_add_u32 s28, s28, 3584
    buffer_load_dwordx4 v[100:103], v56, s[20:23], s28 offen
    buffer_load_dwordx4 v[132:135], v56, s[24:27], s28 offen
    s_add_u32 s28, s28, 3584
    buffer_load_dwordx4 v[104:107], v56, s[20:23], s28 offen
    buffer_load_dwordx4 v[136:139], v56, s[24:27], s28 offen
    s_add_u32 s28, s28, 3584
    buffer_load_dwordx4 v[108:111], v56, s[20:23], s28 offen
    buffer_load_dwordx4 v[140:143], v56, s[24:27], s28 offen
    s_mov_b32 s20, s52
    s_and_b32 s21, s53, 0xffff
    s_mov_b32 s22, 0x1c0000
    s_mov_b32 s23, 0x20000
    v_lshrrev_b32 v56, 4, v0
    v_lshlrev_b32 v56, 13, v56
    v_and_b32 v57, 15, v0
    v_lshl_add_u32 v56, v57, 4, v56
    s_lshl_b32 s28, s69, 15
    s_lshl_b32 s29, s3, 8
    s_add_u32 s28, s28, s29
    buffer_load_dwordx4 v[144:147], v56, s[20:23], s28 offen offset:0
    buffer_load_dwordx4 v[148:151], v56, s[20:23], s28 offen offset:1024
    buffer_load_dwordx4 v[152:155], v56, s[20:23], s28 offen offset:2048
    buffer_load_dwordx4 v[156:159], v56, s[20:23], s28 offen offset:3072
    s_add_u32 s28, s28, 4096
    buffer_load_dwordx4 v[160:163], v56, s[20:23], s28 offen offset:0
    buffer_load_dwordx4 v[164:167], v56, s[20:23], s28 offen offset:1024
    buffer_load_dwordx4 v[168:171], v56, s[20:23], s28 offen offset:2048
    buffer_load_dwordx4 v[172:175], v56, s[20:23], s28 offen offset:3072
L_w_done_2:
    buffer_load_dwordx4 a[0:3], v2, s[8:11], s60 offen offset:0 nt
    buffer_load_dwordx4 a[4:7], v2, s[8:11], s60 offen offset:1024 nt
    buffer_load_dwordx4 a[8:11], v2, s[8:11], s60 offen offset:2048 nt
    buffer_load_dwordx4 a[12:15], v2, s[8:11], s60 offen offset:3072 nt
    buffer_load_dwordx4 a[16:19], v3, s[12:15], s60 offen offset:0 nt
    buffer_load_dwordx4 a[20:23], v3, s[12:15], s60 offen offset:1024 nt
    buffer_load_dwordx4 a[24:27], v3, s[12:15], s60 offen offset:2048 nt
    buffer_load_dwordx4 a[28:31], v3, s[12:15], s60 offen offset:3072 nt
    s_add_u32 s60, s60, s61
    s_waitcnt vmcnt(4)
    buffer_load_dwordx4 a[32:35], v2, s[8:11], s60 offen offset:0 nt
    buffer_load_dwordx4 a[36:39], v2, s[8:11], s60 offen offset:1024 nt
    buffer_load_dwordx4 a[40:43], v2, s[8:11], s60 offen offset:2048 nt
    buffer_load_dwordx4 a[44:47], v2, s[8:11], s60 offen offset:3072 nt
    s_waitcnt vmcnt(4)
    buffer_load_dwordx4 a[48:51], v3, s[12:15], s60 offen offset:0 nt
    buffer_load_dwordx4 a[52:55], v3, s[12:15], s60 offen offset:1024 nt
    buffer_load_dwordx4 a[56:59], v3, s[12:15], s60 offen offset:2048 nt
    buffer_load_dwordx4 a[60:63], v3, s[12:15], s60 offen offset:3072 nt
    s_add_u32 s60, s60, s61
    s_waitcnt vmcnt(4)
    buffer_load_dwordx4 a[64:67], v2, s[8:11], s60 offen offset:0 nt
    buffer_load_dwordx4 a[68:71], v2, s[8:11], s60 offen offset:1024 nt
    buffer_load_dwordx4 a[72:75], v2, s[8:11], s60 offen offset:2048 nt
    buffer_load_dwordx4 a[76:79], v2, s[8:11], s60 offen offset:3072 nt
    s_waitcnt vmcnt(4)
    buffer_load_dwordx4 a[80:83], v3, s[12:15], s60 offen offset:0 nt
    buffer_load_dwordx4 a[84:87], v3, s[12:15], s60 offen offset:1024 nt
    buffer_load_dwordx4 a[88:91], v3, s[12:15], s60 offen offset:2048 nt
    buffer_load_dwordx4 a[92:95], v3, s[12:15], s60 offen offset:3072 nt
    s_add_u32 s60, s60, s61
    s_lshl_b32 s28, s4, 14
    s_add_u32 s28, s28, 65536
    s_mov_b32 s62, 200000
L_poll_q:
    s_add_u32 s29, s28, 0
    buffer_load_dwordx4 v[180:183], v3, s[16:19], s29 offen offset:0 sc1
    buffer_load_dwordx4 v[184:187], v3, s[16:19], s29 offen offset:1024 sc1
    buffer_load_dwordx4 v[188:191], v3, s[16:19], s29 offen offset:2048 sc1
    buffer_load_dwordx4 v[192:195], v3, s[16:19], s29 offen offset:3072 sc1
    s_add_u32 s29, s28, 4096
    buffer_load_dwordx4 v[196:199], v3, s[16:19], s29 offen offset:0 sc1
    buffer_load_dwordx4 v[200:203], v3, s[16:19], s29 offen offset:1024 sc1
    buffer_load_dwordx4 v[204:207], v3, s[16:19], s29 offen offset:2048 sc1
    buffer_load_dwordx4 v[208:211], v3, s[16:19], s29 offen offset:3072 sc1
    s_add_u32 s29, s28, 8192
    buffer_load_dwordx4 v[212:215], v3, s[16:19], s29 offen offset:0 sc1
    buffer_load_dwordx4 v[216:219], v3, s[16:19], s29 offen offset:1024 sc1
    buffer_load_dwordx4 v[220:223], v3, s[16:19], s29 offen offset:2048 sc1
    buffer_load_dwordx4 v[224:227], v3, s[16:19], s29 offen offset:3072 sc1
    s_add_u32 s29, s28, 12288
    buffer_load_dwordx4 v[228:231], v3, s[16:19], s29 offen offset:0 sc1
    buffer_load_dwordx4 v[232:235], v3, s[16:19], s29 offen offset:1024 sc1
    buffer_load_dwordx4 v[236:239], v3, s[16:19], s29 offen offset:2048 sc1
    buffer_load_dwordx4 v[240:243], v3, s[16:19], s29 offen offset:3072 sc1
    s_waitcnt vmcnt(0)
    v_xor_b32 v56, v181, v177
    v_bitop3_b32 v56, v183, v177, v56 bitop3:0xBE
    v_bitop3_b32 v56, v185, v177, v56 bitop3:0xBE
    v_bitop3_b32 v56, v187, v177, v56 bitop3:0xBE
    v_bitop3_b32 v56, v189, v177, v56 bitop3:0xBE
    v_bitop3_b32 v56, v191, v177, v56 bitop3:0xBE
    v_bitop3_b32 v56, v193, v177, v56 bitop3:0xBE
    v_bitop3_b32 v56, v195, v177, v56 bitop3:0xBE
    v_bitop3_b32 v56, v197, v177, v56 bitop3:0xBE
    v_bitop3_b32 v56, v199, v177, v56 bitop3:0xBE
    v_bitop3_b32 v56, v201, v177, v56 bitop3:0xBE
    v_bitop3_b32 v56, v203, v177, v56 bitop3:0xBE
    v_bitop3_b32 v56, v205, v177, v56 bitop3:0xBE
    v_bitop3_b32 v56, v207, v177, v56 bitop3:0xBE
    v_bitop3_b32 v56, v209, v177, v56 bitop3:0xBE
    v_bitop3_b32 v56, v211, v177, v56 bitop3:0xBE
    v_bitop3_b32 v56, v213, v177, v56 bitop3:0xBE
    v_bitop3_b32 v56, v215, v177, v56 bitop3:0xBE
    v_bitop3_b32 v56, v217, v177, v56 bitop3:0xBE
    v_bitop3_b32 v56, v219, v177, v56 bitop3:0xBE
    v_bitop3_b32 v56, v221, v177, v56 bitop3:0xBE
    v_bitop3_b32 v56, v223, v177, v56 bitop3:0xBE
    v_bitop3_b32 v56, v225, v177, v56 bitop3:0xBE
    v_bitop3_b32 v56, v227, v177, v56 bitop3:0xBE
    v_bitop3_b32 v56, v229, v177, v56 bitop3:0xBE
    v_bitop3_b32 v56, v231, v177, v56 bitop3:0xBE
    v_bitop3_b32 v56, v233, v177, v56 bitop3:0xBE
    v_bitop3_b32 v56, v235, v177, v56 bitop3:0xBE
    v_bitop3_b32 v56, v237, v177, v56 bitop3:0xBE
    v_bitop3_b32 v56, v239, v177, v56 bitop3:0xBE
    v_bitop3_b32 v56, v241, v177, v56 bitop3:0xBE
    v_bitop3_b32 v56, v243, v177, v56 bitop3:0xBE
    v_cmp_ne_u32 vcc, 0, v56
    s_cbranch_vccz L_pollok_q
    s_sub_u32 s62, s62, 1
    s_cmp_eq_u32 s62, 0
    s_cbranch_scc0 L_poll_q
L_pollok_q:
    v_add_f32 v180, v180, v196
    v_add_f32 v212, v212, v228
    v_add_f32 v182, v182, v198
    v_add_f32 v214, v214, v230
    v_add_f32 v184, v184, v200
    v_add_f32 v216, v216, v232
    v_add_f32 v186, v186, v202
    v_add_f32 v218, v218, v234
    v_add_f32 v188, v188, v204
    v_add_f32 v220, v220, v236
    v_add_f32 v190, v190, v206
    v_add_f32 v222, v222, v238
    v_add_f32 v192, v192, v208
    v_add_f32 v224, v224, v240
    v_add_f32 v194, v194, v210
    v_add_f32 v226, v226, v242
    v_add_f32 v180, v180, v212
    v_add_f32 v182, v182, v214
    v_add_f32 v184, v184, v216
    v_add_f32 v186, v186, v218
    v_add_f32 v188, v188, v220
    v_add_f32 v190, v190, v222
    v_add_f32 v192, v192, v224
    v_add_f32 v194, v194, v226
    v_lshlrev_b32 v57, 2, v0
    v_cvt_pk_bf16_f32 v24, v180, v182
    ds_write_b32 v57, v24 offset:1024
    v_cvt_pk_bf16_f32 v25, v184, v186
    ds_write_b32 v57, v25 offset:1280
    v_cvt_pk_bf16_f32 v26, v188, v190
    ds_write_b32 v57, v26 offset:1536
    v_cvt_pk_bf16_f32 v27, v192, v194
    ds_write_b32 v57, v27 offset:1792
    buffer_load_dwordx4 a[96:99], v2, s[8:11], s60 offen offset:0 nt
    buffer_load_dwordx4 a[100:103], v2, s[8:11], s60 offen offset:1024 nt
    buffer_load_dwordx4 a[104:107], v2, s[8:11], s60 offen offset:2048 nt
    buffer_load_dwordx4 a[108:111], v2, s[8:11], s60 offen offset:3072 nt
    buffer_load_dwordx4 a[112:115], v3, s[12:15], s60 offen offset:0 nt
    buffer_load_dwordx4 a[116:119], v3, s[12:15], s60 offen offset:1024 nt
    buffer_load_dwordx4 a[120:123], v3, s[12:15], s60 offen offset:2048 nt
    buffer_load_dwordx4 a[124:127], v3, s[12:15], s60 offen offset:3072 nt
    s_add_u32 s60, s60, s61
    buffer_load_dwordx4 a[128:131], v2, s[8:11], s60 offen offset:0 nt
    buffer_load_dwordx4 a[132:135], v2, s[8:11], s60 offen offset:1024 nt
    buffer_load_dwordx4 a[136:139], v2, s[8:11], s60 offen offset:2048 nt
    buffer_load_dwordx4 a[140:143], v2, s[8:11], s60 offen offset:3072 nt
    buffer_load_dwordx4 a[144:147], v3, s[12:15], s60 offen offset:0 nt
    buffer_load_dwordx4 a[148:151], v3, s[12:15], s60 offen offset:1024 nt
    buffer_load_dwordx4 a[152:155], v3, s[12:15], s60 offen offset:2048 nt
    buffer_load_dwordx4 a[156:159], v3, s[12:15], s60 offen offset:3072 nt
    s_add_u32 s60, s60, s61
    buffer_load_dwordx4 a[160:163], v2, s[8:11], s60 offen offset:0 nt
    buffer_load_dwordx4 a[164:167], v2, s[8:11], s60 offen offset:1024 nt
    buffer_load_dwordx4 a[168:171], v2, s[8:11], s60 offen offset:2048 nt
    buffer_load_dwordx4 a[172:175], v2, s[8:11], s60 offen offset:3072 nt
    buffer_load_dwordx4 a[176:179], v3, s[12:15], s60 offen offset:0 nt
    buffer_load_dwordx4 a[180:183], v3, s[12:15], s60 offen offset:1024 nt
    buffer_load_dwordx4 a[184:187], v3, s[12:15], s60 offen offset:2048 nt
    buffer_load_dwordx4 a[188:191], v3, s[12:15], s60 offen offset:3072 nt
    s_add_u32 s60, s60, s61
L_common:
    s_cmp_eq_u32 s3, 0
    s_cbranch_scc1 L_common2
    s_load_dword s7, s[58:59], 0
    s_waitcnt lgkmcnt(0)
    s_add_u32 s7, s7, 1
    s_and_b32 s6, s7, 0xfff
    v_mov_b32 v23, s6
L_common2:
    s_mov_b32 s66, 0x3fb8aa3b
    s_mov_b32 s67, 0xbfb8aa3b
    s_mov_b32 s64, 0x3db504f3
    v_and_b32 v58, 3, v0
    v_mov_b32 v8, 0
    v_mov_b32 v9, 0
    v_mov_b32 v59, 0xffff
    v_mov_b32 v60, 0xffff0000
    v_cmp_eq_u32 vcc, 0, v58
    s_nop 1
    v_cndmask_b32 v8, v8, v59, vcc
    v_cmp_eq_u32 vcc, 1, v58
    s_nop 1
    v_cndmask_b32 v8, v8, v60, vcc
    v_cmp_eq_u32 vcc, 2, v58
    s_nop 1
    v_cndmask_b32 v9, v9, v59, vcc
    v_cmp_eq_u32 vcc, 3, v58
    s_nop 1
    v_cndmask_b32 v9, v9, v60, vcc
    s_add_u32 s28, s3, s5
    s_and_b32 s28, s28, 3
    s_lshl_b32 s29, s28, 12
    s_add_u32 s63, s63, s29
    s_add_u32 s63, s63, 9437184
    s_lshl_b32 s29, s4, 2
    s_add_u32 s29, s29, s28
    s_lshl_b32 s29, s29, 8
    s_add_u32 s29, s29, 4096
    v_mov_b32 v22, s29
    v_mov_b32 v10, 0xf149f2ca
    v_mov_b32 v11, 0
    v_mov_b32 v12, 0
    v_mov_b32 v13, 0
    v_mov_b32 v14, 0
    v_mov_b32 v15, 0
    v_mov_b32 v16, 0
    v_mov_b32 v17, 0
    v_mov_b32 v18, 0
    v_mov_b32 v19, 0
    s_waitcnt lgkmcnt(0)
    s_barrier
    ds_read_b128 v[4:7], v2 offset:1024
L_haveprefetch:
    s_waitcnt lgkmcnt(0)
    s_waitcnt vmcnt(40)
    v_mfma_f32_16x16x32_bf16 v[24:27], a[0:3], v[4:7], 0
    v_mfma_f32_16x16x32_bf16 v[28:31], a[4:7], v[4:7], 0
    v_mfma_f32_16x16x32_bf16 v[32:35], a[8:11], v[4:7], 0
    v_mfma_f32_16x16x32_bf16 v[36:39], a[12:15], v[4:7], 0
    s_nop 4
    v_mov_b32_dpp v40, v24 quad_perm:[0,0,0,0] row_mask:0xf bank_mask:0xf
    v_mov_b32_dpp v41, v28 quad_perm:[0,0,0,0] row_mask:0xf bank_mask:0xf
    v_mov_b32_dpp v42, v32 quad_perm:[0,0,0,0] row_mask:0xf bank_mask:0xf
    v_mov_b32_dpp v43, v36 quad_perm:[0,0,0,0] row_mask:0xf bank_mask:0xf
    v_add_f32_dpp v40, v25, v40 quad_perm:[1,1,1,1] row_mask:0xf bank_mask:0xf
    v_add_f32_dpp v41, v29, v41 quad_perm:[1,1,1,1] row_mask:0xf bank_mask:0xf
    v_add_f32_dpp v42, v33, v42 quad_perm:[1,1,1,1] row_mask:0xf bank_mask:0xf
    v_add_f32_dpp v43, v37, v43 quad_perm:[1,1,1,1] row_mask:0xf bank_mask:0xf
    v_add_f32_dpp v40, v26, v40 quad_perm:[2,2,2,2] row_mask:0xf bank_mask:0xf
    v_add_f32_dpp v41, v30, v41 quad_perm:[2,2,2,2] row_mask:0xf bank_mask:0xf
    v_add_f32_dpp v42, v34, v42 quad_perm:[2,2,2,2] row_mask:0xf bank_mask:0xf
    v_add_f32_dpp v43, v38, v43 quad_perm:[2,2,2,2] row_mask:0xf bank_mask:0xf
    v_add_f32_dpp v40, v27, v40 quad_perm:[3,3,3,3] row_mask:0xf bank_mask:0xf
    v_add_f32_dpp v41, v31, v41 quad_perm:[3,3,3,3] row_mask:0xf bank_mask:0xf
    v_add_f32_dpp v42, v35, v42 quad_perm:[3,3,3,3] row_mask:0xf bank_mask:0xf
    v_add_f32_dpp v43, v39, v43 quad_perm:[3,3,3,3] row_mask:0xf bank_mask:0xf
    v_cvt_pk_bf16_f32 v56, v40, v41
    v_cvt_pk_bf16_f32 v57, v42, v43
    v_lshlrev_b32 v40, 16, v56
    v_and_b32 v41, 0xffff0000, v56
    v_lshlrev_b32 v42, 16, v57
    v_and_b32 v43, 0xffff0000, v57
    v_mul_f32 v40, s64, v40
    v_mul_f32 v41, s64, v41
    v_mul_f32 v42, s64, v42
    v_mul_f32 v43, s64, v43
    v_cvt_pk_bf16_f32 v56, v40, v41
    v_cvt_pk_bf16_f32 v57, v42, v43
    v_lshlrev_b32 v40, 16, v56
    v_and_b32 v41, 0xffff0000, v56
    v_lshlrev_b32 v42, 16, v57
    v_and_b32 v43, 0xffff0000, v57
    v_max3_f32 v56, v40, v41, v42
    v_max3_f32 v56, v56, v43, v10
    v_mov_b32 v57, v56
    s_nop 1
    v_permlane32_swap_b32 v57, v56
    v_max_f32 v56, v56, v57
    v_mov_b32 v57, v56
    s_nop 1
    v_permlane16_swap_b32 v57, v56
    v_max_f32 v56, v56, v57
    v_sub_f32 v59, v10, v56
    v_mul_f32 v58, s67, v56
    v_mul_f32 v59, s66, v59
    v_mov_b32 v10, v56
    v_exp_f32 v59, v59
    v_fma_f32 v44, v40, s66, v58
    v_fma_f32 v45, v41, s66, v58
    v_fma_f32 v46, v42, s66, v58
    v_fma_f32 v47, v43, s66, v58
    v_exp_f32 v44, v44
    v_exp_f32 v45, v45
    v_exp_f32 v46, v46
    v_exp_f32 v47, v47
    v_mul_f32 v12, v12, v59
    v_mul_f32 v13, v13, v59
    v_mul_f32 v14, v14, v59
    v_mul_f32 v15, v15, v59
    v_mul_f32 v16, v16, v59
    v_mul_f32 v17, v17, v59
    v_mul_f32 v18, v18, v59
    v_mul_f32 v19, v19, v59
    v_cvt_pk_bf16_f32 v60, v44, v44
    v_cvt_pk_bf16_f32 v61, v45, v45
    v_cvt_pk_bf16_f32 v62, v46, v46
    v_cvt_pk_bf16_f32 v63, v47, v47
    v_add_f32 v56, v44, v45
    v_add_f32 v57, v46, v47
    v_and_b32 v48, v60, v8
    v_and_b32 v49, v60, v9
    v_and_b32 v50, v61, v8
    v_and_b32 v51, v61, v9
    v_and_b32 v52, v62, v8
    v_and_b32 v53, v62, v9
    v_and_b32 v54, v63, v8
    v_and_b32 v55, v63, v9
    v_add_f32 v56, v56, v57
    v_fma_f32 v11, v11, v59, v56
    v_mfma_f32_16x16x16_bf16 v[12:15], a[16:17], v[48:49], v[12:15]
    v_mfma_f32_16x16x16_bf16 v[16:19], a[18:19], v[48:49], v[16:19]
    v_mfma_f32_16x16x16_bf16 v[12:15], a[20:21], v[50:51], v[12:15]
    v_mfma_f32_16x16x16_bf16 v[16:19], a[22:23], v[50:51], v[16:19]
    v_mfma_f32_16x16x16_bf16 v[12:15], a[24:25], v[52:53], v[12:15]
    v_mfma_f32_16x16x16_bf16 v[16:19], a[26:27], v[52:53], v[16:19]
    v_mfma_f32_16x16x16_bf16 v[12:15], a[28:29], v[54:55], v[12:15]
    v_mfma_f32_16x16x16_bf16 v[16:19], a[30:31], v[54:55], v[16:19]
    buffer_load_dwordx4 a[0:3], v2, s[8:11], s60 offen offset:0 nt
    buffer_load_dwordx4 a[4:7], v2, s[8:11], s60 offen offset:1024 nt
    buffer_load_dwordx4 a[8:11], v2, s[8:11], s60 offen offset:2048 nt
    buffer_load_dwordx4 a[12:15], v2, s[8:11], s60 offen offset:3072 nt
    buffer_load_dwordx4 a[16:19], v3, s[12:15], s60 offen offset:0 nt
    buffer_load_dwordx4 a[20:23], v3, s[12:15], s60 offen offset:1024 nt
    buffer_load_dwordx4 a[24:27], v3, s[12:15], s60 offen offset:2048 nt
    buffer_load_dwordx4 a[28:31], v3, s[12:15], s60 offen offset:3072 nt
    s_add_u32 s60, s60, s61
    s_waitcnt vmcnt(40)
    v_mfma_f32_16x16x32_bf16 v[24:27], a[32:35], v[4:7], 0
    v_mfma_f32_16x16x32_bf16 v[28:31], a[36:39], v[4:7], 0
    v_mfma_f32_16x16x32_bf16 v[32:35], a[40:43], v[4:7], 0
    v_mfma_f32_16x16x32_bf16 v[36:39], a[44:47], v[4:7], 0
    s_nop 4
    v_mov_b32_dpp v40, v24 quad_perm:[0,0,0,0] row_mask:0xf bank_mask:0xf
    v_mov_b32_dpp v41, v28 quad_perm:[0,0,0,0] row_mask:0xf bank_mask:0xf
    v_mov_b32_dpp v42, v32 quad_perm:[0,0,0,0] row_mask:0xf bank_mask:0xf
    v_mov_b32_dpp v43, v36 quad_perm:[0,0,0,0] row_mask:0xf bank_mask:0xf
    v_add_f32_dpp v40, v25, v40 quad_perm:[1,1,1,1] row_mask:0xf bank_mask:0xf
    v_add_f32_dpp v41, v29, v41 quad_perm:[1,1,1,1] row_mask:0xf bank_mask:0xf
    v_add_f32_dpp v42, v33, v42 quad_perm:[1,1,1,1] row_mask:0xf bank_mask:0xf
    v_add_f32_dpp v43, v37, v43 quad_perm:[1,1,1,1] row_mask:0xf bank_mask:0xf
    v_add_f32_dpp v40, v26, v40 quad_perm:[2,2,2,2] row_mask:0xf bank_mask:0xf
    v_add_f32_dpp v41, v30, v41 quad_perm:[2,2,2,2] row_mask:0xf bank_mask:0xf
    v_add_f32_dpp v42, v34, v42 quad_perm:[2,2,2,2] row_mask:0xf bank_mask:0xf
    v_add_f32_dpp v43, v38, v43 quad_perm:[2,2,2,2] row_mask:0xf bank_mask:0xf
    v_add_f32_dpp v40, v27, v40 quad_perm:[3,3,3,3] row_mask:0xf bank_mask:0xf
    v_add_f32_dpp v41, v31, v41 quad_perm:[3,3,3,3] row_mask:0xf bank_mask:0xf
    v_add_f32_dpp v42, v35, v42 quad_perm:[3,3,3,3] row_mask:0xf bank_mask:0xf
    v_add_f32_dpp v43, v39, v43 quad_perm:[3,3,3,3] row_mask:0xf bank_mask:0xf
    v_cvt_pk_bf16_f32 v56, v40, v41
    v_cvt_pk_bf16_f32 v57, v42, v43
    v_lshlrev_b32 v40, 16, v56
    v_and_b32 v41, 0xffff0000, v56
    v_lshlrev_b32 v42, 16, v57
    v_and_b32 v43, 0xffff0000, v57
    v_mul_f32 v40, s64, v40
    v_mul_f32 v41, s64, v41
    v_mul_f32 v42, s64, v42
    v_mul_f32 v43, s64, v43
    v_cvt_pk_bf16_f32 v56, v40, v41
    v_cvt_pk_bf16_f32 v57, v42, v43
    v_lshlrev_b32 v40, 16, v56
    v_and_b32 v41, 0xffff0000, v56
    v_lshlrev_b32 v42, 16, v57
    v_and_b32 v43, 0xffff0000, v57
    v_max3_f32 v56, v40, v41, v42
    v_max3_f32 v56, v56, v43, v10
    v_mov_b32 v57, v56
    s_nop 1
    v_permlane32_swap_b32 v57, v56
    v_max_f32 v56, v56, v57
    v_mov_b32 v57, v56
    s_nop 1
    v_permlane16_swap_b32 v57, v56
    v_max_f32 v56, v56, v57
    v_sub_f32 v59, v10, v56
    v_mul_f32 v58, s67, v56
    v_mul_f32 v59, s66, v59
    v_mov_b32 v10, v56
    v_exp_f32 v59, v59
    v_fma_f32 v44, v40, s66, v58
    v_fma_f32 v45, v41, s66, v58
    v_fma_f32 v46, v42, s66, v58
    v_fma_f32 v47, v43, s66, v58
    v_exp_f32 v44, v44
    v_exp_f32 v45, v45
    v_exp_f32 v46, v46
    v_exp_f32 v47, v47
    v_mul_f32 v12, v12, v59
    v_mul_f32 v13, v13, v59
    v_mul_f32 v14, v14, v59
    v_mul_f32 v15, v15, v59
    v_mul_f32 v16, v16, v59
    v_mul_f32 v17, v17, v59
    v_mul_f32 v18, v18, v59
    v_mul_f32 v19, v19, v59
    v_cvt_pk_bf16_f32 v60, v44, v44
    v_cvt_pk_bf16_f32 v61, v45, v45
    v_cvt_pk_bf16_f32 v62, v46, v46
    v_cvt_pk_bf16_f32 v63, v47, v47
    v_add_f32 v56, v44, v45
    v_add_f32 v57, v46, v47
    v_and_b32 v48, v60, v8
    v_and_b32 v49, v60, v9
    v_and_b32 v50, v61, v8
    v_and_b32 v51, v61, v9
    v_and_b32 v52, v62, v8
    v_and_b32 v53, v62, v9
    v_and_b32 v54, v63, v8
    v_and_b32 v55, v63, v9
    v_add_f32 v56, v56, v57
    v_fma_f32 v11, v11, v59, v56
    v_mfma_f32_16x16x16_bf16 v[12:15], a[48:49], v[48:49], v[12:15]
    v_mfma_f32_16x16x16_bf16 v[16:19], a[50:51], v[48:49], v[16:19]
    v_mfma_f32_16x16x16_bf16 v[12:15], a[52:53], v[50:51], v[12:15]
    v_mfma_f32_16x16x16_bf16 v[16:19], a[54:55], v[50:51], v[16:19]
    v_mfma_f32_16x16x16_bf16 v[12:15], a[56:57], v[52:53], v[12:15]
    v_mfma_f32_16x16x16_bf16 v[16:19], a[58:59], v[52:53], v[16:19]
    v_mfma_f32_16x16x16_bf16 v[12:15], a[60:61], v[54:55], v[12:15]
    v_mfma_f32_16x16x16_bf16 v[16:19], a[62:63], v[54:55], v[16:19]
    s_cmp_eq_u32 s65, 1
    s_cbranch_scc0 L_wopre_1
    s_mov_b32 s28, 0x05040100
    s_mov_b32 s29, 0x07060302
    v_perm_b32 v176, v84, v80, s28
    v_perm_b32 v84, v84, v80, s29
    v_perm_b32 v80, v85, v81, s28
    v_perm_b32 v85, v85, v81, s29
    v_perm_b32 v81, v86, v82, s28
    v_perm_b32 v86, v86, v82, s29
    v_perm_b32 v82, v87, v83, s28
    v_perm_b32 v87, v87, v83, s29
    v_perm_b32 v83, v92, v88, s28
    v_perm_b32 v92, v92, v88, s29
    v_perm_b32 v88, v93, v89, s28
    v_perm_b32 v93, v93, v89, s29
    v_perm_b32 v89, v94, v90, s28
    v_perm_b32 v94, v94, v90, s29
    v_perm_b32 v90, v95, v91, s28
    v_perm_b32 v95, v95, v91, s29
    v_perm_b32 v91, v100, v96, s28
    v_perm_b32 v100, v100, v96, s29
    v_perm_b32 v96, v101, v97, s28
    v_perm_b32 v101, v101, v97, s29
    v_perm_b32 v97, v102, v98, s28
    v_perm_b32 v102, v102, v98, s29
    v_perm_b32 v98, v103, v99, s28
    v_perm_b32 v103, v103, v99, s29
    v_perm_b32 v99, v108, v104, s28
    v_perm_b32 v108, v108, v104, s29
    v_perm_b32 v104, v109, v105, s28
    v_perm_b32 v109, v109, v105, s29
    v_perm_b32 v105, v110, v106, s28
    v_perm_b32 v110, v110, v106, s29
    v_perm_b32 v106, v111, v107, s28
    v_perm_b32 v111, v111, v107, s29
    v_perm_b32 v107, v116, v112, s28
    v_perm_b32 v116, v116, v112, s29
    v_perm_b32 v112, v117, v113, s28
    v_perm_b32 v117, v117, v113, s29
    v_perm_b32 v113, v118, v114, s28
    v_perm_b32 v118, v118, v114, s29
    v_perm_b32 v114, v119, v115, s28
    v_perm_b32 v119, v119, v115, s29
    v_perm_b32 v115, v124, v120, s28
    v_perm_b32 v124, v124, v120, s29
    v_perm_b32 v120, v125, v121, s28
    v_perm_b32 v125, v125, v121, s29
    v_perm_b32 v121, v126, v122, s28
    v_perm_b32 v126, v126, v122, s29
    v_perm_b32 v122, v127, v123, s28
    v_perm_b32 v127, v127, v123, s29
    v_perm_b32 v123, v132, v128, s28
    v_perm_b32 v132, v132, v128, s29
    v_perm_b32 v128, v133, v129, s28
    v_perm_b32 v133, v133, v129, s29
    v_perm_b32 v129, v134, v130, s28
    v_perm_b32 v134, v134, v130, s29
    v_perm_b32 v130, v135, v131, s28
    v_perm_b32 v135, v135, v131, s29
    v_perm_b32 v131, v140, v136, s28
    v_perm_b32 v140, v140, v136, s29
    v_perm_b32 v136, v141, v137, s28
    v_perm_b32 v141, v141, v137, s29
    v_perm_b32 v137, v142, v138, s28
    v_perm_b32 v142, v142, v138, s29
    v_perm_b32 v138, v143, v139, s28
    v_perm_b32 v143, v143, v139, s29
L_wopre_1:
    s_lshr_b32 s30, s2, 5
    s_lshl_b32 s30, s30, 3
    s_and_b32 s47, s2, 7
    s_add_u32 s30, s30, s47
    s_lshr_b32 s47, s2, 3
    s_and_b32 s47, s47, 3
    s_lshr_b32 s31, s30, 1
    s_and_b32 s32, s30, 1
    s_lshl_b32 s32, s32, 1
    s_lshr_b32 s33, s3, 1
    s_add_u32 s32, s32, s33
    s_lshl_b32 s33, s31, 16
    s_lshl_b32 s34, s32, 9
    s_add_u32 s33, s33, s34
    s_and_b32 s34, s3, 1
    s_lshl_b32 s34, s34, 8
    s_add_u32 s33, s33, s34
    s_add_u32 s42, s33, 262144
    s_lshl_b32 s34, s31, 12
    s_lshl_b32 s35, s32, 4
    s_add_u32 s34, s34, s35
    s_add_u32 s43, s34, 786432
    v_lshrrev_b32 v57, 4, v0
    v_and_b32 v58, 15, v0
    v_lshlrev_b32 v64, 11, v57
    v_lshl_add_u32 v64, v58, 4, v64
    v_lshlrev_b32 v65, 7, v57
    v_lshlrev_b32 v66, 3, v58
    v_lshl_add_u32 v66, v57, 1, v66
    s_lshl_b32 s35, s3, 7
    v_add_u32 v66, s35, v66
    v_lshrrev_b32 v69, 2, v0
    v_lshlrev_b32 v69, 5, v69
    v_and_b32 v70, 3, v0
    v_lshlrev_b32 v70, 5, v70
    v_lshrrev_b32 v58, 5, v0
    v_lshl_add_u32 v70, v58, 4, v70
    s_lshl_b32 s46, s30, 11
    s_lshl_b32 s47, s47, 9
    s_add_u32 s46, s46, s47
    s_lshl_b32 s47, s3, 7
    s_add_u32 s46, s46, s47
    s_add_u32 s46, s46, 851968
    v_bfe_u32 v56, v0, 2, 2
    v_mul_u32_u24 v244, 528, v56
    v_lshrrev_b32 v58, 4, v0
    v_lshl_add_u32 v244, v58, 7, v244
    v_and_b32 v58, 3, v0
    v_lshl_add_u32 v244, v58, 2, v244
    s_mul_i32 s28, s3, 2112
    v_add_u32 v244, s28, v244
    v_lshlrev_b32 v245, 5, v56
    s_lshl_b32 s28, s3, 3
    v_add_u32 v245, s28, v245
    v_lshrrev_b32 v56, 5, v1
    v_and_b32 v57, 31, v1
    v_mul_u32_u24 v246, 528, v56
    v_lshl_add_u32 v246, v57, 4, v246
    v_lshlrev_b32 v247, 5, v56
    v_lshlrev_b32 v248, 4, v1
    v_lshlrev_b32 v249, 4, v56
    s_lshl_b32 s28, s4, 5
    s_add_u32 s28, s28, s5
    s_lshl_b32 s92, s28, 11
    s_add_u32 s92, s92, 262144
    s_lshl_b32 s93, s28, 7
    s_add_u32 s93, s93, 786432
    s_waitcnt vmcnt(32)
    v_mfma_f32_16x16x32_bf16 v[24:27], a[64:67], v[4:7], 0
    v_mfma_f32_16x16x32_bf16 v[28:31], a[68:71], v[4:7], 0
    v_mfma_f32_16x16x32_bf16 v[32:35], a[72:75], v[4:7], 0
    v_mfma_f32_16x16x32_bf16 v[36:39], a[76:79], v[4:7], 0
    s_nop 4
    v_mov_b32_dpp v40, v24 quad_perm:[0,0,0,0] row_mask:0xf bank_mask:0xf
    v_mov_b32_dpp v41, v28 quad_perm:[0,0,0,0] row_mask:0xf bank_mask:0xf
    v_mov_b32_dpp v42, v32 quad_perm:[0,0,0,0] row_mask:0xf bank_mask:0xf
    v_mov_b32_dpp v43, v36 quad_perm:[0,0,0,0] row_mask:0xf bank_mask:0xf
    v_add_f32_dpp v40, v25, v40 quad_perm:[1,1,1,1] row_mask:0xf bank_mask:0xf
    v_add_f32_dpp v41, v29, v41 quad_perm:[1,1,1,1] row_mask:0xf bank_mask:0xf
    v_add_f32_dpp v42, v33, v42 quad_perm:[1,1,1,1] row_mask:0xf bank_mask:0xf
    v_add_f32_dpp v43, v37, v43 quad_perm:[1,1,1,1] row_mask:0xf bank_mask:0xf
    v_add_f32_dpp v40, v26, v40 quad_perm:[2,2,2,2] row_mask:0xf bank_mask:0xf
    v_add_f32_dpp v41, v30, v41 quad_perm:[2,2,2,2] row_mask:0xf bank_mask:0xf
    v_add_f32_dpp v42, v34, v42 quad_perm:[2,2,2,2] row_mask:0xf bank_mask:0xf
    v_add_f32_dpp v43, v38, v43 quad_perm:[2,2,2,2] row_mask:0xf bank_mask:0xf
    v_add_f32_dpp v40, v27, v40 quad_perm:[3,3,3,3] row_mask:0xf bank_mask:0xf
    v_add_f32_dpp v41, v31, v41 quad_perm:[3,3,3,3] row_mask:0xf bank_mask:0xf
    v_add_f32_dpp v42, v35, v42 quad_perm:[3,3,3,3] row_mask:0xf bank_mask:0xf
    v_add_f32_dpp v43, v39, v43 quad_perm:[3,3,3,3] row_mask:0xf bank_mask:0xf
    v_cvt_pk_bf16_f32 v56, v40, v41
    v_cvt_pk_bf16_f32 v57, v42, v43
    v_lshlrev_b32 v40, 16, v56
    v_and_b32 v41, 0xffff0000, v56
    v_lshlrev_b32 v42, 16, v57
    v_and_b32 v43, 0xffff0000, v57
    v_mul_f32 v40, s64, v40
    v_mul_f32 v41, s64, v41
    v_mul_f32 v42, s64, v42
    v_mul_f32 v43, s64, v43
    v_cvt_pk_bf16_f32 v56, v40, v41
    v_cvt_pk_bf16_f32 v57, v42, v43
    v_lshlrev_b32 v40, 16, v56
    v_and_b32 v41, 0xffff0000, v56
    v_lshlrev_b32 v42, 16, v57
    v_and_b32 v43, 0xffff0000, v57
    v_max3_f32 v56, v40, v41, v42
    v_max3_f32 v56, v56, v43, v10
    v_mov_b32 v57, v56
    s_nop 1
    v_permlane32_swap_b32 v57, v56
    v_max_f32 v56, v56, v57
    v_mov_b32 v57, v56
    s_nop 1
    v_permlane16_swap_b32 v57, v56
    v_max_f32 v56, v56, v57
    v_sub_f32 v59, v10, v56
    v_mul_f32 v58, s67, v56
    v_mul_f32 v59, s66, v59
    v_mov_b32 v10, v56
    v_exp_f32 v59, v59
    v_fma_f32 v44, v40, s66, v58
    v_fma_f32 v45, v41, s66, v58
    v_fma_f32 v46, v42, s66, v58
    v_fma_f32 v47, v43, s66, v58
    v_exp_f32 v44, v44
    v_exp_f32 v45, v45
    v_exp_f32 v46, v46
    v_exp_f32 v47, v47
    v_mul_f32 v12, v12, v59
    v_mul_f32 v13, v13, v59
    v_mul_f32 v14, v14, v59
    v_mul_f32 v15, v15, v59
    v_mul_f32 v16, v16, v59
    v_mul_f32 v17, v17, v59
    v_mul_f32 v18, v18, v59
    v_mul_f32 v19, v19, v59
    v_cvt_pk_bf16_f32 v60, v44, v44
    v_cvt_pk_bf16_f32 v61, v45, v45
    v_cvt_pk_bf16_f32 v62, v46, v46
    v_cvt_pk_bf16_f32 v63, v47, v47
    v_add_f32 v56, v44, v45
    v_add_f32 v57, v46, v47
    v_and_b32 v48, v60, v8
    v_and_b32 v49, v60, v9
    v_and_b32 v50, v61, v8
    v_and_b32 v51, v61, v9
    v_and_b32 v52, v62, v8
    v_and_b32 v53, v62, v9
    v_and_b32 v54, v63, v8
    v_and_b32 v55, v63, v9
    v_add_f32 v56, v56, v57
    v_fma_f32 v11, v11, v59, v56
    v_mfma_f32_16x16x16_bf16 v[12:15], a[80:81], v[48:49], v[12:15]
    v_mfma_f32_16x16x16_bf16 v[16:19], a[82:83], v[48:49], v[16:19]
    v_mfma_f32_16x16x16_bf16 v[12:15], a[84:85], v[50:51], v[12:15]
    v_mfma_f32_16x16x16_bf16 v[16:19], a[86:87], v[50:51], v[16:19]
    v_mfma_f32_16x16x16_bf16 v[12:15], a[88:89], v[52:53], v[12:15]
    v_mfma_f32_16x16x16_bf16 v[16:19], a[90:91], v[52:53], v[16:19]
    v_mfma_f32_16x16x16_bf16 v[12:15], a[92:93], v[54:55], v[12:15]
    v_mfma_f32_16x16x16_bf16 v[16:19], a[94:95], v[54:55], v[16:19]
    s_waitcnt vmcnt(24)
    v_mfma_f32_16x16x32_bf16 v[24:27], a[96:99], v[4:7], 0
    v_mfma_f32_16x16x32_bf16 v[28:31], a[100:103], v[4:7], 0
    v_mfma_f32_16x16x32_bf16 v[32:35], a[104:107], v[4:7], 0
    v_mfma_f32_16x16x32_bf16 v[36:39], a[108:111], v[4:7], 0
    s_nop 4
    v_mov_b32_dpp v40, v24 quad_perm:[0,0,0,0] row_mask:0xf bank_mask:0xf
    v_mov_b32_dpp v41, v28 quad_perm:[0,0,0,0] row_mask:0xf bank_mask:0xf
    v_mov_b32_dpp v42, v32 quad_perm:[0,0,0,0] row_mask:0xf bank_mask:0xf
    v_mov_b32_dpp v43, v36 quad_perm:[0,0,0,0] row_mask:0xf bank_mask:0xf
    v_add_f32_dpp v40, v25, v40 quad_perm:[1,1,1,1] row_mask:0xf bank_mask:0xf
    v_add_f32_dpp v41, v29, v41 quad_perm:[1,1,1,1] row_mask:0xf bank_mask:0xf
    v_add_f32_dpp v42, v33, v42 quad_perm:[1,1,1,1] row_mask:0xf bank_mask:0xf
    v_add_f32_dpp v43, v37, v43 quad_perm:[1,1,1,1] row_mask:0xf bank_mask:0xf
    v_add_f32_dpp v40, v26, v40 quad_perm:[2,2,2,2] row_mask:0xf bank_mask:0xf
    v_add_f32_dpp v41, v30, v41 quad_perm:[2,2,2,2] row_mask:0xf bank_mask:0xf
    v_add_f32_dpp v42, v34, v42 quad_perm:[2,2,2,2] row_mask:0xf bank_mask:0xf
    v_add_f32_dpp v43, v38, v43 quad_perm:[2,2,2,2] row_mask:0xf bank_mask:0xf
    v_add_f32_dpp v40, v27, v40 quad_perm:[3,3,3,3] row_mask:0xf bank_mask:0xf
    v_add_f32_dpp v41, v31, v41 quad_perm:[3,3,3,3] row_mask:0xf bank_mask:0xf
    v_add_f32_dpp v42, v35, v42 quad_perm:[3,3,3,3] row_mask:0xf bank_mask:0xf
    v_add_f32_dpp v43, v39, v43 quad_perm:[3,3,3,3] row_mask:0xf bank_mask:0xf
    v_cvt_pk_bf16_f32 v56, v40, v41
    v_cvt_pk_bf16_f32 v57, v42, v43
    v_lshlrev_b32 v40, 16, v56
    v_and_b32 v41, 0xffff0000, v56
    v_lshlrev_b32 v42, 16, v57
    v_and_b32 v43, 0xffff0000, v57
    v_mul_f32 v40, s64, v40
    v_mul_f32 v41, s64, v41
    v_mul_f32 v42, s64, v42
    v_mul_f32 v43, s64, v43
    v_cvt_pk_bf16_f32 v56, v40, v41
    v_cvt_pk_bf16_f32 v57, v42, v43
    v_lshlrev_b32 v40, 16, v56
    v_and_b32 v41, 0xffff0000, v56
    v_lshlrev_b32 v42, 16, v57
    v_and_b32 v43, 0xffff0000, v57
    v_max3_f32 v56, v40, v41, v42
    v_max3_f32 v56, v56, v43, v10
    v_mov_b32 v57, v56
    s_nop 1
    v_permlane32_swap_b32 v57, v56
    v_max_f32 v56, v56, v57
    v_mov_b32 v57, v56
    s_nop 1
    v_permlane16_swap_b32 v57, v56
    v_max_f32 v56, v56, v57
    v_sub_f32 v59, v10, v56
    v_mul_f32 v58, s67, v56
    v_mul_f32 v59, s66, v59
    v_mov_b32 v10, v56
    v_exp_f32 v59, v59
    v_fma_f32 v44, v40, s66, v58
    v_fma_f32 v45, v41, s66, v58
    v_fma_f32 v46, v42, s66, v58
    v_fma_f32 v47, v43, s66, v58
    v_exp_f32 v44, v44
    v_exp_f32 v45, v45
    v_exp_f32 v46, v46
    v_exp_f32 v47, v47
    v_mul_f32 v12, v12, v59
    v_mul_f32 v13, v13, v59
    v_mul_f32 v14, v14, v59
    v_mul_f32 v15, v15, v59
    v_mul_f32 v16, v16, v59
    v_mul_f32 v17, v17, v59
    v_mul_f32 v18, v18, v59
    v_mul_f32 v19, v19, v59
    v_cvt_pk_bf16_f32 v60, v44, v44
    v_cvt_pk_bf16_f32 v61, v45, v45
    v_cvt_pk_bf16_f32 v62, v46, v46
    v_cvt_pk_bf16_f32 v63, v47, v47
    v_add_f32 v56, v44, v45
    v_add_f32 v57, v46, v47
    v_and_b32 v48, v60, v8
    v_and_b32 v49, v60, v9
    v_and_b32 v50, v61, v8
    v_and_b32 v51, v61, v9
    v_and_b32 v52, v62, v8
    v_and_b32 v53, v62, v9
    v_and_b32 v54, v63, v8
    v_and_b32 v55, v63, v9
    v_add_f32 v56, v56, v57
    v_fma_f32 v11, v11, v59, v56
    v_mfma_f32_16x16x16_bf16 v[12:15], a[112:113], v[48:49], v[12:15]
    v_mfma_f32_16x16x16_bf16 v[16:19], a[114:115], v[48:49], v[16:19]
    v_mfma_f32_16x16x16_bf16 v[12:15], a[116:117], v[50:51], v[12:15]
    v_mfma_f32_16x16x16_bf16 v[16:19], a[118:119], v[50:51], v[16:19]
    v_mfma_f32_16x16x16_bf16 v[12:15], a[120:121], v[52:53], v[12:15]
    v_mfma_f32_16x16x16_bf16 v[16:19], a[122:123], v[52:53], v[16:19]
    v_mfma_f32_16x16x16_bf16 v[12:15], a[124:125], v[54:55], v[12:15]
    v_mfma_f32_16x16x16_bf16 v[16:19], a[126:127], v[54:55], v[16:19]
    buffer_load_dwordx4 a[32:35], v2, s[8:11], s60 offen offset:0 nt
    buffer_load_dwordx4 a[36:39], v2, s[8:11], s60 offen offset:1024 nt
    buffer_load_dwordx4 a[40:43], v2, s[8:11], s60 offen offset:2048 nt
    buffer_load_dwordx4 a[44:47], v2, s[8:11], s60 offen offset:3072 nt
    buffer_load_dwordx4 a[48:51], v3, s[12:15], s60 offen offset:0 nt
    buffer_load_dwordx4 a[52:55], v3, s[12:15], s60 offen offset:1024 nt
    buffer_load_dwordx4 a[56:59], v3, s[12:15], s60 offen offset:2048 nt
    buffer_load_dwordx4 a[60:63], v3, s[12:15], s60 offen offset:3072 nt
    s_add_u32 s60, s60, s61
    s_waitcnt vmcnt(24)
    v_mfma_f32_16x16x32_bf16 v[24:27], a[128:131], v[4:7], 0
    v_mfma_f32_16x16x32_bf16 v[28:31], a[132:135], v[4:7], 0
    v_mfma_f32_16x16x32_bf16 v[32:35], a[136:139], v[4:7], 0
    v_mfma_f32_16x16x32_bf16 v[36:39], a[140:143], v[4:7], 0
    s_nop 4
    v_mov_b32_dpp v40, v24 quad_perm:[0,0,0,0] row_mask:0xf bank_mask:0xf
    v_mov_b32_dpp v41, v28 quad_perm:[0,0,0,0] row_mask:0xf bank_mask:0xf
    v_mov_b32_dpp v42, v32 quad_perm:[0,0,0,0] row_mask:0xf bank_mask:0xf
    v_mov_b32_dpp v43, v36 quad_perm:[0,0,0,0] row_mask:0xf bank_mask:0xf
    v_add_f32_dpp v40, v25, v40 quad_perm:[1,1,1,1] row_mask:0xf bank_mask:0xf
    v_add_f32_dpp v41, v29, v41 quad_perm:[1,1,1,1] row_mask:0xf bank_mask:0xf
    v_add_f32_dpp v42, v33, v42 quad_perm:[1,1,1,1] row_mask:0xf bank_mask:0xf
    v_add_f32_dpp v43, v37, v43 quad_perm:[1,1,1,1] row_mask:0xf bank_mask:0xf
    v_add_f32_dpp v40, v26, v40 quad_perm:[2,2,2,2] row_mask:0xf bank_mask:0xf
    v_add_f32_dpp v41, v30, v41 quad_perm:[2,2,2,2] row_mask:0xf bank_mask:0xf
    v_add_f32_dpp v42, v34, v42 quad_perm:[2,2,2,2] row_mask:0xf bank_mask:0xf
    v_add_f32_dpp v43, v38, v43 quad_perm:[2,2,2,2] row_mask:0xf bank_mask:0xf
    v_add_f32_dpp v40, v27, v40 quad_perm:[3,3,3,3] row_mask:0xf bank_mask:0xf
    v_add_f32_dpp v41, v31, v41 quad_perm:[3,3,3,3] row_mask:0xf bank_mask:0xf
    v_add_f32_dpp v42, v35, v42 quad_perm:[3,3,3,3] row_mask:0xf bank_mask:0xf
    v_add_f32_dpp v43, v39, v43 quad_perm:[3,3,3,3] row_mask:0xf bank_mask:0xf
    v_cvt_pk_bf16_f32 v56, v40, v41
    v_cvt_pk_bf16_f32 v57, v42, v43
    v_lshlrev_b32 v40, 16, v56
    v_and_b32 v41, 0xffff0000, v56
    v_lshlrev_b32 v42, 16, v57
    v_and_b32 v43, 0xffff0000, v57
    v_mul_f32 v40, s64, v40
    v_mul_f32 v41, s64, v41
    v_mul_f32 v42, s64, v42
    v_mul_f32 v43, s64, v43
    v_cvt_pk_bf16_f32 v56, v40, v41
    v_cvt_pk_bf16_f32 v57, v42, v43
    v_lshlrev_b32 v40, 16, v56
    v_and_b32 v41, 0xffff0000, v56
    v_lshlrev_b32 v42, 16, v57
    v_and_b32 v43, 0xffff0000, v57
    v_max3_f32 v56, v40, v41, v42
    v_max3_f32 v56, v56, v43, v10
    v_mov_b32 v57, v56
    s_nop 1
    v_permlane32_swap_b32 v57, v56
    v_max_f32 v56, v56, v57
    v_mov_b32 v57, v56
    s_nop 1
    v_permlane16_swap_b32 v57, v56
    v_max_f32 v56, v56, v57
    v_sub_f32 v59, v10, v56
    v_mul_f32 v58, s67, v56
    v_mul_f32 v59, s66, v59
    v_mov_b32 v10, v56
    v_exp_f32 v59, v59
    v_fma_f32 v44, v40, s66, v58
    v_fma_f32 v45, v41, s66, v58
    v_fma_f32 v46, v42, s66, v58
    v_fma_f32 v47, v43, s66, v58
    v_exp_f32 v44, v44
    v_exp_f32 v45, v45
    v_exp_f32 v46, v46
    v_exp_f32 v47, v47
    v_mul_f32 v12, v12, v59
    v_mul_f32 v13, v13, v59
    v_mul_f32 v14, v14, v59
    v_mul_f32 v15, v15, v59
    v_mul_f32 v16, v16, v59
    v_mul_f32 v17, v17, v59
    v_mul_f32 v18, v18, v59
    v_mul_f32 v19, v19, v59
    v_cvt_pk_bf16_f32 v60, v44, v44
    v_cvt_pk_bf16_f32 v61, v45, v45
    v_cvt_pk_bf16_f32 v62, v46, v46
    v_cvt_pk_bf16_f32 v63, v47, v47
    v_add_f32 v56, v44, v45
    v_add_f32 v57, v46, v47
    v_and_b32 v48, v60, v8
    v_and_b32 v49, v60, v9
    v_and_b32 v50, v61, v8
    v_and_b32 v51, v61, v9
    v_and_b32 v52, v62, v8
    v_and_b32 v53, v62, v9
    v_and_b32 v54, v63, v8
    v_and_b32 v55, v63, v9
    v_add_f32 v56, v56, v57
    v_fma_f32 v11, v11, v59, v56
    v_mfma_f32_16x16x16_bf16 v[12:15], a[144:145], v[48:49], v[12:15]
    v_mfma_f32_16x16x16_bf16 v[16:19], a[146:147], v[48:49], v[16:19]
    v_mfma_f32_16x16x16_bf16 v[12:15], a[148:149], v[50:51], v[12:15]
    v_mfma_f32_16x16x16_bf16 v[16:19], a[150:151], v[50:51], v[16:19]
    v_mfma_f32_16x16x16_bf16 v[12:15], a[152:153], v[52:53], v[12:15]
    v_mfma_f32_16x16x16_bf16 v[16:19], a[154:155], v[52:53], v[16:19]
    v_mfma_f32_16x16x16_bf16 v[12:15], a[156:157], v[54:55], v[12:15]
    v_mfma_f32_16x16x16_bf16 v[16:19], a[158:159], v[54:55], v[16:19]
    s_waitcnt vmcnt(16)
    v_mfma_f32_16x16x32_bf16 v[24:27], a[160:163], v[4:7], 0
    v_mfma_f32_16x16x32_bf16 v[28:31], a[164:167], v[4:7], 0
    v_mfma_f32_16x16x32_bf16 v[32:35], a[168:171], v[4:7], 0
    v_mfma_f32_16x16x32_bf16 v[36:39], a[172:175], v[4:7], 0
    s_nop 4
    v_mov_b32_dpp v40, v24 quad_perm:[0,0,0,0] row_mask:0xf bank_mask:0xf
    v_mov_b32_dpp v41, v28 quad_perm:[0,0,0,0] row_mask:0xf bank_mask:0xf
    v_mov_b32_dpp v42, v32 quad_perm:[0,0,0,0] row_mask:0xf bank_mask:0xf
    v_mov_b32_dpp v43, v36 quad_perm:[0,0,0,0] row_mask:0xf bank_mask:0xf
    v_add_f32_dpp v40, v25, v40 quad_perm:[1,1,1,1] row_mask:0xf bank_mask:0xf
    v_add_f32_dpp v41, v29, v41 quad_perm:[1,1,1,1] row_mask:0xf bank_mask:0xf
    v_add_f32_dpp v42, v33, v42 quad_perm:[1,1,1,1] row_mask:0xf bank_mask:0xf
    v_add_f32_dpp v43, v37, v43 quad_perm:[1,1,1,1] row_mask:0xf bank_mask:0xf
    v_add_f32_dpp v40, v26, v40 quad_perm:[2,2,2,2] row_mask:0xf bank_mask:0xf
    v_add_f32_dpp v41, v30, v41 quad_perm:[2,2,2,2] row_mask:0xf bank_mask:0xf
    v_add_f32_dpp v42, v34, v42 quad_perm:[2,2,2,2] row_mask:0xf bank_mask:0xf
    v_add_f32_dpp v43, v38, v43 quad_perm:[2,2,2,2] row_mask:0xf bank_mask:0xf
    v_add_f32_dpp v40, v27, v40 quad_perm:[3,3,3,3] row_mask:0xf bank_mask:0xf
    v_add_f32_dpp v41, v31, v41 quad_perm:[3,3,3,3] row_mask:0xf bank_mask:0xf
    v_add_f32_dpp v42, v35, v42 quad_perm:[3,3,3,3] row_mask:0xf bank_mask:0xf
    v_add_f32_dpp v43, v39, v43 quad_perm:[3,3,3,3] row_mask:0xf bank_mask:0xf
    v_cvt_pk_bf16_f32 v56, v40, v41
    v_cvt_pk_bf16_f32 v57, v42, v43
    v_lshlrev_b32 v40, 16, v56
    v_and_b32 v41, 0xffff0000, v56
    v_lshlrev_b32 v42, 16, v57
    v_and_b32 v43, 0xffff0000, v57
    v_mul_f32 v40, s64, v40
    v_mul_f32 v41, s64, v41
    v_mul_f32 v42, s64, v42
    v_mul_f32 v43, s64, v43
    v_cvt_pk_bf16_f32 v56, v40, v41
    v_cvt_pk_bf16_f32 v57, v42, v43
    v_lshlrev_b32 v40, 16, v56
    v_and_b32 v41, 0xffff0000, v56
    v_lshlrev_b32 v42, 16, v57
    v_and_b32 v43, 0xffff0000, v57
    v_max3_f32 v56, v40, v41, v42
    v_max3_f32 v56, v56, v43, v10
    v_mov_b32 v57, v56
    s_nop 1
    v_permlane32_swap_b32 v57, v56
    v_max_f32 v56, v56, v57
    v_mov_b32 v57, v56
    s_nop 1
    v_permlane16_swap_b32 v57, v56
    v_max_f32 v56, v56, v57
    v_sub_f32 v59, v10, v56
    v_mul_f32 v58, s67, v56
    v_mul_f32 v59, s66, v59
    v_mov_b32 v10, v56
    v_exp_f32 v59, v59
    v_fma_f32 v44, v40, s66, v58
    v_fma_f32 v45, v41, s66, v58
    v_fma_f32 v46, v42, s66, v58
    v_fma_f32 v47, v43, s66, v58
    v_exp_f32 v44, v44
    v_exp_f32 v45, v45
    v_exp_f32 v46, v46
    v_exp_f32 v47, v47
    v_mul_f32 v12, v12, v59
    v_mul_f32 v13, v13, v59
    v_mul_f32 v14, v14, v59
    v_mul_f32 v15, v15, v59
    v_mul_f32 v16, v16, v59
    v_mul_f32 v17, v17, v59
    v_mul_f32 v18, v18, v59
    v_mul_f32 v19, v19, v59
    v_cvt_pk_bf16_f32 v60, v44, v44
    v_cvt_pk_bf16_f32 v61, v45, v45
    v_cvt_pk_bf16_f32 v62, v46, v46
    v_cvt_pk_bf16_f32 v63, v47, v47
    v_add_f32 v56, v44, v45
    v_add_f32 v57, v46, v47
    v_and_b32 v48, v60, v8
    v_and_b32 v49, v60, v9
    v_and_b32 v50, v61, v8
    v_and_b32 v51, v61, v9
    v_and_b32 v52, v62, v8
    v_and_b32 v53, v62, v9
    v_and_b32 v54, v63, v8
    v_and_b32 v55, v63, v9
    v_add_f32 v56, v56, v57
    v_fma_f32 v11, v11, v59, v56
    v_mfma_f32_16x16x16_bf16 v[12:15], a[176:177], v[48:49], v[12:15]
    v_mfma_f32_16x16x16_bf16 v[16:19], a[178:179], v[48:49], v[16:19]
    v_mfma_f32_16x16x16_bf16 v[12:15], a[180:181], v[50:51], v[12:15]
    v_mfma_f32_16x16x16_bf16 v[16:19], a[182:183], v[50:51], v[16:19]
    v_mfma_f32_16x16x16_bf16 v[12:15], a[184:185], v[52:53], v[12:15]
    v_mfma_f32_16x16x16_bf16 v[16:19], a[186:187], v[52:53], v[16:19]
    v_mfma_f32_16x16x16_bf16 v[12:15], a[188:189], v[54:55], v[12:15]
    v_mfma_f32_16x16x16_bf16 v[16:19], a[190:191], v[54:55], v[16:19]
    s_cmp_eq_u32 s3, 3
    s_cbranch_scc0 L_dryret
    s_mov_b64 s[90:91], 0
    s_mov_b64 exec, 0
    s_branch L_done
L_dryback:
    s_mov_b64 s[90:91], -1
    s_mov_b64 exec, -1
L_dryret:
    s_waitcnt vmcnt(8)
    v_mfma_f32_16x16x32_bf16 v[24:27], a[0:3], v[4:7], 0
    v_mfma_f32_16x16x32_bf16 v[28:31], a[4:7], v[4:7], 0
    v_mfma_f32_16x16x32_bf16 v[32:35], a[8:11], v[4:7], 0
    v_mfma_f32_16x16x32_bf16 v[36:39], a[12:15], v[4:7], 0
    s_nop 4
    v_mov_b32_dpp v40, v24 quad_perm:[0,0,0,0] row_mask:0xf bank_mask:0xf
    v_mov_b32_dpp v41, v28 quad_perm:[0,0,0,0] row_mask:0xf bank_mask:0xf
    v_mov_b32_dpp v42, v32 quad_perm:[0,0,0,0] row_mask:0xf bank_mask:0xf
    v_mov_b32_dpp v43, v36 quad_perm:[0,0,0,0] row_mask:0xf bank_mask:0xf
    v_add_f32_dpp v40, v25, v40 quad_perm:[1,1,1,1] row_mask:0xf bank_mask:0xf
    v_add_f32_dpp v41, v29, v41 quad_perm:[1,1,1,1] row_mask:0xf bank_mask:0xf
    v_add_f32_dpp v42, v33, v42 quad_perm:[1,1,1,1] row_mask:0xf bank_mask:0xf
    v_add_f32_dpp v43, v37, v43 quad_perm:[1,1,1,1] row_mask:0xf bank_mask:0xf
    v_add_f32_dpp v40, v26, v40 quad_perm:[2,2,2,2] row_mask:0xf bank_mask:0xf
    v_add_f32_dpp v41, v30, v41 quad_perm:[2,2,2,2] row_mask:0xf bank_mask:0xf
    v_add_f32_dpp v42, v34, v42 quad_perm:[2,2,2,2] row_mask:0xf bank_mask:0xf
    v_add_f32_dpp v43, v38, v43 quad_perm:[2,2,2,2] row_mask:0xf bank_mask:0xf
    v_add_f32_dpp v40, v27, v40 quad_perm:[3,3,3,3] row_mask:0xf bank_mask:0xf
    v_add_f32_dpp v41, v31, v41 quad_perm:[3,3,3,3] row_mask:0xf bank_mask:0xf
    v_add_f32_dpp v42, v35, v42 quad_perm:[3,3,3,3] row_mask:0xf bank_mask:0xf
    v_add_f32_dpp v43, v39, v43 quad_perm:[3,3,3,3] row_mask:0xf bank_mask:0xf
    v_cvt_pk_bf16_f32 v56, v40, v41
    v_cvt_pk_bf16_f32 v57, v42, v43
    v_lshlrev_b32 v40, 16, v56
    v_and_b32 v41, 0xffff0000, v56
    v_lshlrev_b32 v42, 16, v57
    v_and_b32 v43, 0xffff0000, v57
    v_mul_f32 v40, s64, v40
    v_mul_f32 v41, s64, v41
    v_mul_f32 v42, s64, v42
    v_mul_f32 v43, s64, v43
    v_cvt_pk_bf16_f32 v56, v40, v41
    v_cvt_pk_bf16_f32 v57, v42, v43
    v_lshlrev_b32 v40, 16, v56
    v_and_b32 v41, 0xffff0000, v56
    v_lshlrev_b32 v42, 16, v57
    v_and_b32 v43, 0xffff0000, v57
    v_max3_f32 v56, v40, v41, v42
    v_max3_f32 v56, v56, v43, v10
    v_mov_b32 v57, v56
    s_nop 1
    v_permlane32_swap_b32 v57, v56
    v_max_f32 v56, v56, v57
    v_mov_b32 v57, v56
    s_nop 1
    v_permlane16_swap_b32 v57, v56
    v_max_f32 v56, v56, v57
    v_sub_f32 v59, v10, v56
    v_mul_f32 v58, s67, v56
    v_mul_f32 v59, s66, v59
    v_mov_b32 v10, v56
    v_exp_f32 v59, v59
    v_fma_f32 v44, v40, s66, v58
    v_fma_f32 v45, v41, s66, v58
    v_fma_f32 v46, v42, s66, v58
    v_fma_f32 v47, v43, s66, v58
    v_exp_f32 v44, v44
    v_exp_f32 v45, v45
    v_exp_f32 v46, v46
    v_exp_f32 v47, v47
    v_mul_f32 v12, v12, v59
    v_mul_f32 v13, v13, v59
    v_mul_f32 v14, v14, v59
    v_mul_f32 v15, v15, v59
    v_mul_f32 v16, v16, v59
    v_mul_f32 v17, v17, v59
    v_mul_f32 v18, v18, v59
    v_mul_f32 v19, v19, v59
    v_cvt_pk_bf16_f32 v60, v44, v44
    v_cvt_pk_bf16_f32 v61, v45, v45
    v_cvt_pk_bf16_f32 v62, v46, v46
    v_cvt_pk_bf16_f32 v63, v47, v47
    v_add_f32 v56, v44, v45
    v_add_f32 v57, v46, v47
    v_and_b32 v48, v60, v8
    v_and_b32 v49, v60, v9
    v_and_b32 v50, v61, v8
    v_and_b32 v51, v61, v9
    v_and_b32 v52, v62, v8
    v_and_b32 v53, v62, v9
    v_and_b32 v54, v63, v8
    v_and_b32 v55, v63, v9
    v_add_f32 v56, v56, v57
    v_fma_f32 v11, v11, v59, v56
    v_mfma_f32_16x16x16_bf16 v[12:15], a[16:17], v[48:49], v[12:15]
    v_mfma_f32_16x16x16_bf16 v[16:19], a[18:19], v[48:49], v[16:19]
    v_mfma_f32_16x16x16_bf16 v[12:15], a[20:21], v[50:51], v[12:15]
    v_mfma_f32_16x16x16_bf16 v[16:19], a[22:23], v[50:51], v[16:19]
    v_mfma_f32_16x16x16_bf16 v[12:15], a[24:25], v[52:53], v[12:15]
    v_mfma_f32_16x16x16_bf16 v[16:19], a[26:27], v[52:53], v[16:19]
    v_mfma_f32_16x16x16_bf16 v[12:15], a[28:29], v[54:55], v[12:15]
    v_mfma_f32_16x16x16_bf16 v[16:19], a[30:31], v[54:55], v[16:19]
    s_mov_b32 s88, 10
L_dloop:
    s_waitcnt vmcnt(0)
    s_cmp_eq_u32 s88, 0
    s_cbranch_scc1 L_dyn_1
    s_mov_b32 s28, s60
    s_add_u32 s60, s60, s61
    s_sub_u32 s88, s88, 1
    s_mov_b32 s101, 0
    s_cmp_eq_u32 s88, 0
    s_cbranch_scc0 L_issue_1
    v_mov_b32 v21, 1
    s_mov_b64 exec, 1
    buffer_atomic_add v21, v22, s[16:19], 0 offen sc0
    s_mov_b64 exec, -1
    s_branch L_issue_1
L_dyn_1:
    v_readfirstlane_b32 s28, v20
    s_cmp_ge_u32 s28, 448
    s_cselect_b32 s101, 1, 0
    s_cbranch_scc1 L_noissue_1
    v_mov_b32 v21, 1
    s_mov_b64 exec, 1
    buffer_atomic_add v21, v22, s[16:19], 0 offen sc0
    s_mov_b64 exec, -1
    s_lshl_b32 s28, s28, 14
    s_add_u32 s28, s28, s63
L_issue_1:
    buffer_load_dwordx4 a[0:3], v2, s[8:11], s28 offen offset:0 nt
    buffer_load_dwordx4 a[4:7], v2, s[8:11], s28 offen offset:1024 nt
    buffer_load_dwordx4 a[8:11], v2, s[8:11], s28 offen offset:2048 nt
    buffer_load_dwordx4 a[12:15], v2, s[8:11], s28 offen offset:3072 nt
    buffer_load_dwordx4 a[16:19], v3, s[12:15], s28 offen offset:0 nt
    buffer_load_dwordx4 a[20:23], v3, s[12:15], s28 offen offset:1024 nt
    buffer_load_dwordx4 a[24:27], v3, s[12:15], s28 offen offset:2048 nt
    buffer_load_dwordx4 a[28:31], v3, s[12:15], s28 offen offset:3072 nt
L_noissue_1:
    v_mfma_f32_16x16x32_bf16 v[24:27], a[32:35], v[4:7], 0
    v_mfma_f32_16x16x32_bf16 v[28:31], a[36:39], v[4:7], 0
    v_mfma_f32_16x16x32_bf16 v[32:35], a[40:43], v[4:7], 0
    v_mfma_f32_16x16x32_bf16 v[36:39], a[44:47], v[4:7], 0
    s_nop 4
    v_mov_b32_dpp v40, v24 quad_perm:[0,0,0,0] row_mask:0xf bank_mask:0xf
    v_mov_b32_dpp v41, v28 quad_perm:[0,0,0,0] row_mask:0xf bank_mask:0xf
    v_mov_b32_dpp v42, v32 quad_perm:[0,0,0,0] row_mask:0xf bank_mask:0xf
    v_mov_b32_dpp v43, v36 quad_perm:[0,0,0,0] row_mask:0xf bank_mask:0xf
    v_add_f32_dpp v40, v25, v40 quad_perm:[1,1,1,1] row_mask:0xf bank_mask:0xf
    v_add_f32_dpp v41, v29, v41 quad_perm:[1,1,1,1] row_mask:0xf bank_mask:0xf
    v_add_f32_dpp v42, v33, v42 quad_perm:[1,1,1,1] row_mask:0xf bank_mask:0xf
    v_add_f32_dpp v43, v37, v43 quad_perm:[1,1,1,1] row_mask:0xf bank_mask:0xf
    v_add_f32_dpp v40, v26, v40 quad_perm:[2,2,2,2] row_mask:0xf bank_mask:0xf
    v_add_f32_dpp v41, v30, v41 quad_perm:[2,2,2,2] row_mask:0xf bank_mask:0xf
    v_add_f32_dpp v42, v34, v42 quad_perm:[2,2,2,2] row_mask:0xf bank_mask:0xf
    v_add_f32_dpp v43, v38, v43 quad_perm:[2,2,2,2] row_mask:0xf bank_mask:0xf
    v_add_f32_dpp v40, v27, v40 quad_perm:[3,3,3,3] row_mask:0xf bank_mask:0xf
    v_add_f32_dpp v41, v31, v41 quad_perm:[3,3,3,3] row_mask:0xf bank_mask:0xf
    v_add_f32_dpp v42, v35, v42 quad_perm:[3,3,3,3] row_mask:0xf bank_mask:0xf
    v_add_f32_dpp v43, v39, v43 quad_perm:[3,3,3,3] row_mask:0xf bank_mask:0xf
    v_cvt_pk_bf16_f32 v56, v40, v41
    v_cvt_pk_bf16_f32 v57, v42, v43
    v_lshlrev_b32 v40, 16, v56
    v_and_b32 v41, 0xffff0000, v56
    v_lshlrev_b32 v42, 16, v57
    v_and_b32 v43, 0xffff0000, v57
    v_mul_f32 v40, s64, v40
    v_mul_f32 v41, s64, v41
    v_mul_f32 v42, s64, v42
    v_mul_f32 v43, s64, v43
    v_cvt_pk_bf16_f32 v56, v40, v41
    v_cvt_pk_bf16_f32 v57, v42, v43
    v_lshlrev_b32 v40, 16, v56
    v_and_b32 v41, 0xffff0000, v56
    v_lshlrev_b32 v42, 16, v57
    v_and_b32 v43, 0xffff0000, v57
    v_max3_f32 v56, v40, v41, v42
    v_max3_f32 v56, v56, v43, v10
    v_mov_b32 v57, v56
    s_nop 1
    v_permlane32_swap_b32 v57, v56
    v_max_f32 v56, v56, v57
    v_mov_b32 v57, v56
    s_nop 1
    v_permlane16_swap_b32 v57, v56
    v_max_f32 v56, v56, v57
    v_sub_f32 v59, v10, v56
    v_mul_f32 v58, s67, v56
    v_mul_f32 v59, s66, v59
    v_mov_b32 v10, v56
    v_exp_f32 v59, v59
    v_fma_f32 v44, v40, s66, v58
    v_fma_f32 v45, v41, s66, v58
    v_fma_f32 v46, v42, s66, v58
    v_fma_f32 v47, v43, s66, v58
    v_exp_f32 v44, v44
    v_exp_f32 v45, v45
    v_exp_f32 v46, v46
    v_exp_f32 v47, v47
    v_mul_f32 v12, v12, v59
    v_mul_f32 v13, v13, v59
    v_mul_f32 v14, v14, v59
    v_mul_f32 v15, v15, v59
    v_mul_f32 v16, v16, v59
    v_mul_f32 v17, v17, v59
    v_mul_f32 v18, v18, v59
    v_mul_f32 v19, v19, v59
    v_cvt_pk_bf16_f32 v60, v44, v44
    v_cvt_pk_bf16_f32 v61, v45, v45
    v_cvt_pk_bf16_f32 v62, v46, v46
    v_cvt_pk_bf16_f32 v63, v47, v47
    v_add_f32 v56, v44, v45
    v_add_f32 v57, v46, v47
    v_and_b32 v48, v60, v8
    v_and_b32 v49, v60, v9
    v_and_b32 v50, v61, v8
    v_and_b32 v51, v61, v9
    v_and_b32 v52, v62, v8
    v_and_b32 v53, v62, v9
    v_and_b32 v54, v63, v8
    v_and_b32 v55, v63, v9
    v_add_f32 v56, v56, v57
    v_fma_f32 v11, v11, v59, v56
    v_mfma_f32_16x16x16_bf16 v[12:15], a[48:49], v[48:49], v[12:15]
    v_mfma_f32_16x16x16_bf16 v[16:19], a[50:51], v[48:49], v[16:19]
    v_mfma_f32_16x16x16_bf16 v[12:15], a[52:53], v[50:51], v[12:15]
    v_mfma_f32_16x16x16_bf16 v[16:19], a[54:55], v[50:51], v[16:19]
    v_mfma_f32_16x16x16_bf16 v[12:15], a[56:57], v[52:53], v[12:15]
    v_mfma_f32_16x16x16_bf16 v[16:19], a[58:59], v[52:53], v[16:19]
    v_mfma_f32_16x16x16_bf16 v[12:15], a[60:61], v[54:55], v[12:15]
    v_mfma_f32_16x16x16_bf16 v[16:19], a[62:63], v[54:55], v[16:19]
    s_cmp_eq_u32 s101, 1
    s_cbranch_scc1 L_fin
    s_waitcnt vmcnt(0)
    s_cmp_eq_u32 s88, 0
    s_cbranch_scc1 L_dyn_0
    s_mov_b32 s28, s60
    s_add_u32 s60, s60, s61
    s_sub_u32 s88, s88, 1
    s_mov_b32 s101, 0
    s_cmp_eq_u32 s88, 0
    s_cbranch_scc0 L_issue_0
    v_mov_b32 v20, 1
    s_mov_b64 exec, 1
    buffer_atomic_add v20, v22, s[16:19], 0 offen sc0
    s_mov_b64 exec, -1
    s_branch L_issue_0
L_dyn_0:
    v_readfirstlane_b32 s28, v21
    s_cmp_ge_u32 s28, 448
    s_cselect_b32 s101, 1, 0
    s_cbranch_scc1 L_noissue_0
    v_mov_b32 v20, 1
    s_mov_b64 exec, 1
    buffer_atomic_add v20, v22, s[16:19], 0 offen sc0
    s_mov_b64 exec, -1
    s_lshl_b32 s28, s28, 14
    s_add_u32 s28, s28, s63
L_issue_0:
    buffer_load_dwordx4 a[32:35], v2, s[8:11], s28 offen offset:0 nt
    buffer_load_dwordx4 a[36:39], v2, s[8:11], s28 offen offset:1024 nt
    buffer_load_dwordx4 a[40:43], v2, s[8:11], s28 offen offset:2048 nt
    buffer_load_dwordx4 a[44:47], v2, s[8:11], s28 offen offset:3072 nt
    buffer_load_dwordx4 a[48:51], v3, s[12:15], s28 offen offset:0 nt
    buffer_load_dwordx4 a[52:55], v3, s[12:15], s28 offen offset:1024 nt
    buffer_load_dwordx4 a[56:59], v3, s[12:15], s28 offen offset:2048 nt
    buffer_load_dwordx4 a[60:63], v3, s[12:15], s28 offen offset:3072 nt
L_noissue_0:
    v_mfma_f32_16x16x32_bf16 v[24:27], a[0:3], v[4:7], 0
    v_mfma_f32_16x16x32_bf16 v[28:31], a[4:7], v[4:7], 0
    v_mfma_f32_16x16x32_bf16 v[32:35], a[8:11], v[4:7], 0
    v_mfma_f32_16x16x32_bf16 v[36:39], a[12:15], v[4:7], 0
    s_nop 4
    v_mov_b32_dpp v40, v24 quad_perm:[0,0,0,0] row_mask:0xf bank_mask:0xf
    v_mov_b32_dpp v41, v28 quad_perm:[0,0,0,0] row_mask:0xf bank_mask:0xf
    v_mov_b32_dpp v42, v32 quad_perm:[0,0,0,0] row_mask:0xf bank_mask:0xf
    v_mov_b32_dpp v43, v36 quad_perm:[0,0,0,0] row_mask:0xf bank_mask:0xf
    v_add_f32_dpp v40, v25, v40 quad_perm:[1,1,1,1] row_mask:0xf bank_mask:0xf
    v_add_f32_dpp v41, v29, v41 quad_perm:[1,1,1,1] row_mask:0xf bank_mask:0xf
    v_add_f32_dpp v42, v33, v42 quad_perm:[1,1,1,1] row_mask:0xf bank_mask:0xf
    v_add_f32_dpp v43, v37, v43 quad_perm:[1,1,1,1] row_mask:0xf bank_mask:0xf
    v_add_f32_dpp v40, v26, v40 quad_perm:[2,2,2,2] row_mask:0xf bank_mask:0xf
    v_add_f32_dpp v41, v30, v41 quad_perm:[2,2,2,2] row_mask:0xf bank_mask:0xf
    v_add_f32_dpp v42, v34, v42 quad_perm:[2,2,2,2] row_mask:0xf bank_mask:0xf
    v_add_f32_dpp v43, v38, v43 quad_perm:[2,2,2,2] row_mask:0xf bank_mask:0xf
    v_add_f32_dpp v40, v27, v40 quad_perm:[3,3,3,3] row_mask:0xf bank_mask:0xf
    v_add_f32_dpp v41, v31, v41 quad_perm:[3,3,3,3] row_mask:0xf bank_mask:0xf
    v_add_f32_dpp v42, v35, v42 quad_perm:[3,3,3,3] row_mask:0xf bank_mask:0xf
    v_add_f32_dpp v43, v39, v43 quad_perm:[3,3,3,3] row_mask:0xf bank_mask:0xf
    v_cvt_pk_bf16_f32 v56, v40, v41
    v_cvt_pk_bf16_f32 v57, v42, v43
    v_lshlrev_b32 v40, 16, v56
    v_and_b32 v41, 0xffff0000, v56
    v_lshlrev_b32 v42, 16, v57
    v_and_b32 v43, 0xffff0000, v57
    v_mul_f32 v40, s64, v40
    v_mul_f32 v41, s64, v41
    v_mul_f32 v42, s64, v42
    v_mul_f32 v43, s64, v43
    v_cvt_pk_bf16_f32 v56, v40, v41
    v_cvt_pk_bf16_f32 v57, v42, v43
    v_lshlrev_b32 v40, 16, v56
    v_and_b32 v41, 0xffff0000, v56
    v_lshlrev_b32 v42, 16, v57
    v_and_b32 v43, 0xffff0000, v57
    v_max3_f32 v56, v40, v41, v42
    v_max3_f32 v56, v56, v43, v10
    v_mov_b32 v57, v56
    s_nop 1
    v_permlane32_swap_b32 v57, v56
    v_max_f32 v56, v56, v57
    v_mov_b32 v57, v56
    s_nop 1
    v_permlane16_swap_b32 v57, v56
    v_max_f32 v56, v56, v57
    v_sub_f32 v59, v10, v56
    v_mul_f32 v58, s67, v56
    v_mul_f32 v59, s66, v59
    v_mov_b32 v10, v56
    v_exp_f32 v59, v59
    v_fma_f32 v44, v40, s66, v58
    v_fma_f32 v45, v41, s66, v58
    v_fma_f32 v46, v42, s66, v58
    v_fma_f32 v47, v43, s66, v58
    v_exp_f32 v44, v44
    v_exp_f32 v45, v45
    v_exp_f32 v46, v46
    v_exp_f32 v47, v47
    v_mul_f32 v12, v12, v59
    v_mul_f32 v13, v13, v59
    v_mul_f32 v14, v14, v59
    v_mul_f32 v15, v15, v59
    v_mul_f32 v16, v16, v59
    v_mul_f32 v17, v17, v59
    v_mul_f32 v18, v18, v59
    v_mul_f32 v19, v19, v59
    v_cvt_pk_bf16_f32 v60, v44, v44
    v_cvt_pk_bf16_f32 v61, v45, v45
    v_cvt_pk_bf16_f32 v62, v46, v46
    v_cvt_pk_bf16_f32 v63, v47, v47
    v_add_f32 v56, v44, v45
    v_add_f32 v57, v46, v47
    v_and_b32 v48, v60, v8
    v_and_b32 v49, v60, v9
    v_and_b32 v50, v61, v8
    v_and_b32 v51, v61, v9
    v_and_b32 v52, v62, v8
    v_and_b32 v53, v62, v9
    v_and_b32 v54, v63, v8
    v_and_b32 v55, v63, v9
    v_add_f32 v56, v56, v57
    v_fma_f32 v11, v11, v59, v56
    v_mfma_f32_16x16x16_bf16 v[12:15], a[16:17], v[48:49], v[12:15]
    v_mfma_f32_16x16x16_bf16 v[16:19], a[18:19], v[48:49], v[16:19]
    v_mfma_f32_16x16x16_bf16 v[12:15], a[20:21], v[50:51], v[12:15]
    v_mfma_f32_16x16x16_bf16 v[16:19], a[22:23], v[50:51], v[16:19]
    v_mfma_f32_16x16x16_bf16 v[12:15], a[24:25], v[52:53], v[12:15]
    v_mfma_f32_16x16x16_bf16 v[16:19], a[26:27], v[52:53], v[16:19]
    v_mfma_f32_16x16x16_bf16 v[12:15], a[28:29], v[54:55], v[12:15]
    v_mfma_f32_16x16x16_bf16 v[16:19], a[30:31], v[54:55], v[16:19]
    s_cmp_eq_u32 s101, 1
    s_cbranch_scc1 L_fin
    s_branch L_dloop
L_fin:
    s_waitcnt vmcnt(0)
L_done:
    s_nop 3
    ds_write_b32 v244, v12 offset:2048
    ds_write_b32 v244, v13 offset:2080
    ds_write_b32 v244, v14 offset:2112
    ds_write_b32 v244, v15 offset:2144
    ds_write_b32 v244, v16 offset:2064
    ds_write_b32 v244, v17 offset:2096
    ds_write_b32 v244, v18 offset:2128
    ds_write_b32 v244, v19 offset:2160
    v_mov_b32 v61, v11
    v_mov_b32 v56, v61
    s_nop 1
    v_permlane16_swap_b32 v56, v61
    v_add_f32 v61, v61, v56
    v_mov_b32 v56, v61
    s_nop 1
    v_permlane32_swap_b32 v56, v61
    v_add_f32 v61, v61, v56
    v_mov_b32 v60, v10
    s_and_b32 exec_lo, s90, 0x1111
    s_and_b32 exec_hi, s91, 0x0
    ds_write_b64 v245, v[60:61] offset:10496
    s_mov_b64 exec, s[90:91]
    s_waitcnt lgkmcnt(0)
    s_cmp_eq_u32 s90, 0
    s_cbranch_scc1 L_nobar_2
    s_barrier
L_nobar_2:
    s_cmp_lt_u32 s3, 2
    s_cselect_b32 s28, 1, 0
    s_cmp_eq_u32 s90, 0
    s_cselect_b32 s28, 1, s28
    s_cmp_eq_u32 s28, 0
    s_cbranch_scc1 L_s0_done
    ds_read_b128 v[40:43], v247 offset:10496
    ds_read_b128 v[44:47], v247 offset:10512
    ds_read_b128 v[24:27], v246 offset:2048
    ds_read_b128 v[28:31], v246 offset:4160
    ds_read_b128 v[32:35], v246 offset:6272
    ds_read_b128 v[36:39], v246 offset:8384
    s_waitcnt lgkmcnt(4)
    v_max3_f32 v60, v40, v42, v44
    v_max_f32 v60, v60, v46
    v_and_b32 v60, 0xfffff000, v60
    v_sub_f32 v40, v40, v60
    v_sub_f32 v42, v42, v60
    v_sub_f32 v44, v44, v60
    v_sub_f32 v46, v46, v60
    v_mul_f32 v40, s66, v40
    v_mul_f32 v42, s66, v42
    v_mul_f32 v44, s66, v44
    v_mul_f32 v46, s66, v46
    v_exp_f32 v40, v40
    v_exp_f32 v42, v42
    v_exp_f32 v44, v44
    v_exp_f32 v46, v46
    v_mov_b32 v62, v60
    v_mul_f32 v61, v40, v41
    v_fma_f32 v61, v42, v43, v61
    v_fma_f32 v61, v44, v45, v61
    v_fma_f32 v61, v46, v47, v61
    s_waitcnt lgkmcnt(0)
    v_mul_f32 v24, v24, v40
    v_mul_f32 v25, v25, v40
    v_mul_f32 v26, v26, v40
    v_mul_f32 v27, v27, v40
    v_fma_f32 v24, v28, v42, v24
    v_fma_f32 v25, v29, v42, v25
    v_fma_f32 v26, v30, v42, v26
    v_fma_f32 v27, v31, v42, v27
    v_fma_f32 v24, v32, v44, v24
    v_fma_f32 v25, v33, v44, v25
    v_fma_f32 v26, v34, v44, v26
    v_fma_f32 v27, v35, v44, v27
    v_fma_f32 v24, v36, v46, v24
    v_fma_f32 v25, v37, v46, v25
    v_fma_f32 v26, v38, v46, v26
    v_fma_f32 v27, v39, v46, v27
    v_bfi_b32 v24, s68, v23, v24
    v_bfi_b32 v25, s68, v23, v25
    v_bfi_b32 v26, s68, v23, v26
    v_bfi_b32 v27, s68, v23, v27
    s_cmp_eq_u32 s90, 0
    s_cbranch_scc1 L_nost_3
    buffer_store_dwordx4 v[24:27], v248, s[16:19], s92 offen sc1
L_nost_3:
    v_mov_b32 v63, v61
    v_bfi_b32 v60, s68, v23, v60
    v_bfi_b32 v61, s68, v23, v61
    v_bfi_b32 v62, s68, v23, v62
    v_bfi_b32 v63, s68, v23, v63
    s_and_b32 exec_lo, s90, 0x1
    s_and_b32 exec_hi, s91, 0x1
    s_cmp_eq_u32 s90, 0
    s_cbranch_scc1 L_nost_4
    buffer_store_dwordx4 v[60:63], v249, s[16:19], s93 offen sc1
L_nost_4:
    s_mov_b64 exec, s[90:91]
L_s0_done:
    s_cmp_eq_u32 s65, 1
    s_cbranch_scc1 L_role_wo
    s_cmp_eq_u32 s65, 2
    s_cbranch_scc1 L_role_ffn
    s_cmp_eq_u32 s65, 3
    s_cbranch_scc1 L_role_red
    s_branch L_exit
L_role_wo:
    s_mov_b32 s62, 200000
L_poll_A0:
    s_cmp_eq_u32 s90, 0
    s_cbranch_scc1 L_dryld_5
    buffer_load_dwordx4 v[212:215], v65, s[16:19], s43 offen offset:0 sc1
    buffer_load_dwordx4 v[216:219], v65, s[16:19], s43 offen offset:512 sc1
    buffer_load_dwordx4 v[220:223], v65, s[16:19], s43 offen offset:1024 sc1
    buffer_load_dwordx4 v[224:227], v65, s[16:19], s43 offen offset:1536 sc1
    buffer_load_dwordx4 v[228:231], v65, s[16:19], s43 offen offset:2048 sc1
    buffer_load_dwordx4 v[232:235], v65, s[16:19], s43 offen offset:2560 sc1
    buffer_load_dwordx4 v[236:239], v65, s[16:19], s43 offen offset:3072 sc1
    buffer_load_dwordx4 v[240:243], v65, s[16:19], s43 offen offset:3584 sc1
L_dryld_5:
    s_waitcnt vmcnt(7)
    v_xor_b32 v79, v212, v23
    v_bitop3_b32 v79, v213, v23, v79 bitop3:0xBE
    s_waitcnt vmcnt(6)
    v_bitop3_b32 v79, v216, v23, v79 bitop3:0xBE
    v_bitop3_b32 v79, v217, v23, v79 bitop3:0xBE
    s_waitcnt vmcnt(5)
    v_bitop3_b32 v79, v220, v23, v79 bitop3:0xBE
    v_bitop3_b32 v79, v221, v23, v79 bitop3:0xBE
    s_waitcnt vmcnt(4)
    v_bitop3_b32 v79, v224, v23, v79 bitop3:0xBE
    v_bitop3_b32 v79, v225, v23, v79 bitop3:0xBE
    s_waitcnt vmcnt(3)
    v_bitop3_b32 v79, v228, v23, v79 bitop3:0xBE
    v_bitop3_b32 v79, v229, v23, v79 bitop3:0xBE
    s_waitcnt vmcnt(2)
    v_bitop3_b32 v79, v232, v23, v79 bitop3:0xBE
    v_bitop3_b32 v79, v233, v23, v79 bitop3:0xBE
    s_waitcnt vmcnt(1)
    v_bitop3_b32 v79, v236, v23, v79 bitop3:0xBE
    v_bitop3_b32 v79, v237, v23, v79 bitop3:0xBE
    s_waitcnt vmcnt(0)
    v_bitop3_b32 v79, v240, v23, v79 bitop3:0xBE
    v_bitop3_b32 v79, v241, v23, v79 bitop3:0xBE
    v_and_b32 v79, 0xfff, v79
    v_cmp_ne_u32 vcc, 0, v79
    s_cbranch_vccz L_pollok_A0
L_pollretry_A0:
    s_sub_u32 s62, s62, 1
    s_cmp_eq_u32 s62, 0
    s_cbranch_scc0 L_poll_A0
L_pollok_A0:
    s_mov_b32 s62, 200000
    s_cmp_eq_u32 s90, 0
    s_cbranch_scc1 L_dryld_6
    s_add_u32 s35, s42, 0
    buffer_load_dwordx4 v[180:183], v64, s[16:19], s35 offen sc1
    s_add_u32 s35, s42, 8192
    buffer_load_dwordx4 v[184:187], v64, s[16:19], s35 offen sc1
    s_add_u32 s35, s42, 16384
    buffer_load_dwordx4 v[188:191], v64, s[16:19], s35 offen sc1
    s_add_u32 s35, s42, 24576
    buffer_load_dwordx4 v[192:195], v64, s[16:19], s35 offen sc1
    s_add_u32 s35, s42, 32768
    buffer_load_dwordx4 v[196:199], v64, s[16:19], s35 offen sc1
    s_add_u32 s35, s42, 40960
    buffer_load_dwordx4 v[200:203], v64, s[16:19], s35 offen sc1
    s_add_u32 s35, s42, 49152
    buffer_load_dwordx4 v[204:207], v64, s[16:19], s35 offen sc1
    s_add_u32 s35, s42, 57344
    buffer_load_dwordx4 v[208:211], v64, s[16:19], s35 offen sc1
L_dryld_6:
    v_and_b32 v40, 0xfffff000, v212
    v_and_b32 v41, 0xfffff000, v216
    v_and_b32 v42, 0xfffff000, v220
    v_and_b32 v43, 0xfffff000, v224
    v_and_b32 v44, 0xfffff000, v228
    v_and_b32 v45, 0xfffff000, v232
    v_and_b32 v46, 0xfffff000, v236
    v_and_b32 v47, 0xfffff000, v240
    v_max3_f32 v56, v40, v41, v42
    v_max3_f32 v57, v43, v44, v45
    v_max3_f32 v56, v56, v46, v47
    v_max_f32 v56, v56, v57
    v_mov_b32 v57, v56
    s_nop 1
    v_permlane32_swap_b32 v57, v56
    v_max_f32 v56, v56, v57
    v_mov_b32 v57, v56
    s_nop 1
    v_permlane16_swap_b32 v57, v56
    v_max_f32 v56, v56, v57
    v_mul_f32 v56, s67, v56
    v_fma_f32 v40, v40, s66, v56
    v_fma_f32 v41, v41, s66, v56
    v_fma_f32 v42, v42, s66, v56
    v_fma_f32 v43, v43, s66, v56
    v_fma_f32 v44, v44, s66, v56
    v_fma_f32 v45, v45, s66, v56
    v_fma_f32 v46, v46, s66, v56
    v_fma_f32 v47, v47, s66, v56
    v_exp_f32 v40, v40
    v_exp_f32 v41, v41
    v_exp_f32 v42, v42
    v_exp_f32 v43, v43
    v_exp_f32 v44, v44
    v_exp_f32 v45, v45
    v_exp_f32 v46, v46
    v_exp_f32 v47, v47
    v_mul_f32 v58, v40, v213
    v_fma_f32 v58, v41, v217, v58
    v_fma_f32 v58, v42, v221, v58
    v_fma_f32 v58, v43, v225, v58
    v_fma_f32 v58, v44, v229, v58
    v_fma_f32 v58, v45, v233, v58
    v_fma_f32 v58, v46, v237, v58
    v_fma_f32 v58, v47, v241, v58
    v_mov_b32 v57, v58
    s_nop 1
    v_permlane32_swap_b32 v57, v58
    v_add_f32 v58, v58, v57
    v_mov_b32 v57, v58
    s_nop 1
    v_permlane16_swap_b32 v57, v58
    v_add_f32 v58, v58, v57
    v_rcp_f32 v58, v58
    s_branch L_pollwait_A
L_poll_A:
    s_cmp_eq_u32 s90, 0
    s_cbranch_scc1 L_dryld_7
    s_add_u32 s35, s42, 0
    buffer_load_dwordx4 v[180:183], v64, s[16:19], s35 offen sc1
    s_add_u32 s35, s42, 8192
    buffer_load_dwordx4 v[184:187], v64, s[16:19], s35 offen sc1
    s_add_u32 s35, s42, 16384
    buffer_load_dwordx4 v[188:191], v64, s[16:19], s35 offen sc1
    s_add_u32 s35, s42, 24576
    buffer_load_dwordx4 v[192:195], v64, s[16:19], s35 offen sc1
    s_add_u32 s35, s42, 32768
    buffer_load_dwordx4 v[196:199], v64, s[16:19], s35 offen sc1
    s_add_u32 s35, s42, 40960
    buffer_load_dwordx4 v[200:203], v64, s[16:19], s35 offen sc1
    s_add_u32 s35, s42, 49152
    buffer_load_dwordx4 v[204:207], v64, s[16:19], s35 offen sc1
    s_add_u32 s35, s42, 57344
    buffer_load_dwordx4 v[208:211], v64, s[16:19], s35 offen sc1
L_dryld_7:
L_pollwait_A:
    s_waitcnt vmcnt(7)
    v_xor_b32 v79, v180, v23
    v_bitop3_b32 v79, v181, v23, v79 bitop3:0xBE
    v_bitop3_b32 v79, v182, v23, v79 bitop3:0xBE
    v_bitop3_b32 v79, v183, v23, v79 bitop3:0xBE
    v_mul_f32 v32, v180, v40
    v_mul_f32 v33, v181, v40
    v_mul_f32 v34, v182, v40
    v_mul_f32 v35, v183, v40
    s_waitcnt vmcnt(6)
    v_bitop3_b32 v79, v184, v23, v79 bitop3:0xBE
    v_bitop3_b32 v79, v185, v23, v79 bitop3:0xBE
    v_bitop3_b32 v79, v186, v23, v79 bitop3:0xBE
    v_bitop3_b32 v79, v187, v23, v79 bitop3:0xBE
    v_fma_f32 v32, v184, v41, v32
    v_fma_f32 v33, v185, v41, v33
    v_fma_f32 v34, v186, v41, v34
    v_fma_f32 v35, v187, v41, v35
    s_waitcnt vmcnt(5)
    v_bitop3_b32 v79, v188, v23, v79 bitop3:0xBE
    v_bitop3_b32 v79, v189, v23, v79 bitop3:0xBE
    v_bitop3_b32 v79, v190, v23, v79 bitop3:0xBE
    v_bitop3_b32 v79, v191, v23, v79 bitop3:0xBE
    v_fma_f32 v32, v188, v42, v32
    v_fma_f32 v33, v189, v42, v33
    v_fma_f32 v34, v190, v42, v34
    v_fma_f32 v35, v191, v42, v35
    s_waitcnt vmcnt(4)
    v_bitop3_b32 v79, v192, v23, v79 bitop3:0xBE
    v_bitop3_b32 v79, v193, v23, v79 bitop3:0xBE
    v_bitop3_b32 v79, v194, v23, v79 bitop3:0xBE
    v_bitop3_b32 v79, v195, v23, v79 bitop3:0xBE
    v_fma_f32 v32, v192, v43, v32
    v_fma_f32 v33, v193, v43, v33
    v_fma_f32 v34, v194, v43, v34
    v_fma_f32 v35, v195, v43, v35
    s_waitcnt vmcnt(3)
    v_bitop3_b32 v79, v196, v23, v79 bitop3:0xBE
    v_bitop3_b32 v79, v197, v23, v79 bitop3:0xBE
    v_bitop3_b32 v79, v198, v23, v79 bitop3:0xBE
    v_bitop3_b32 v79, v199, v23, v79 bitop3:0xBE
    v_fma_f32 v32, v196, v44, v32
    v_fma_f32 v33, v197, v44, v33
    v_fma_f32 v34, v198, v44, v34
    v_fma_f32 v35, v199, v44, v35
    s_waitcnt vmcnt(2)
    v_bitop3_b32 v79, v200, v23, v79 bitop3:0xBE
    v_bitop3_b32 v79, v201, v23, v79 bitop3:0xBE
    v_bitop3_b32 v79, v202, v23, v79 bitop3:0xBE
    v_bitop3_b32 v79, v203, v23, v79 bitop3:0xBE
    v_fma_f32 v32, v200, v45, v32
    v_fma_f32 v33, v201, v45, v33
    v_fma_f32 v34, v202, v45, v34
    v_fma_f32 v35, v203, v45, v35
    s_waitcnt vmcnt(1)
    v_bitop3_b32 v79, v204, v23, v79 bitop3:0xBE
    v_bitop3_b32 v79, v205, v23, v79 bitop3:0xBE
    v_bitop3_b32 v79, v206, v23, v79 bitop3:0xBE
    v_bitop3_b32 v79, v207, v23, v79 bitop3:0xBE
    v_fma_f32 v32, v204, v46, v32
    v_fma_f32 v33, v205, v46, v33
    v_fma_f32 v34, v206, v46, v34
    v_fma_f32 v35, v207, v46, v35
    s_waitcnt vmcnt(0)
    v_bitop3_b32 v79, v208, v23, v79 bitop3:0xBE
    v_bitop3_b32 v79, v209, v23, v79 bitop3:0xBE
    v_bitop3_b32 v79, v210, v23, v79 bitop3:0xBE
    v_bitop3_b32 v79, v211, v23, v79 bitop3:0xBE
    v_fma_f32 v32, v208, v47, v32
    v_fma_f32 v33, v209, v47, v33
    v_fma_f32 v34, v210, v47, v34
    v_fma_f32 v35, v211, v47, v35
    v_and_b32 v79, 0xfff, v79
    v_cmp_ne_u32 vcc, 0, v79
    s_cbranch_vccz L_pollok_A
L_pollretry_A:
    s_sub_u32 s62, s62, 1
    s_cmp_eq_u32 s62, 0
    s_cbranch_scc0 L_poll_A
L_pollok_A:
    v_permlane32_swap_b32 v32, v34
    v_permlane32_swap_b32 v33, v35
    v_add_f32 v32, v32, v34
    v_add_f32 v33, v33, v35
    s_nop 1
    v_permlane16_swap_b32 v32, v33
    v_add_f32 v32, v32, v33
    v_mul_f32 v32, v32, v58
    v_cvt_pk_bf16_f32 v32, v32, v32
    ds_write_b16 v66, v32 offset:10752
    s_waitcnt lgkmcnt(0)
    s_cmp_eq_u32 s90, 0
    s_cbranch_scc1 L_nobar_8
    s_barrier
L_nobar_8:
    ds_read_b128 v[40:43], v69 offset:10752
    ds_read_b128 v[44:47], v69 offset:10768
    s_waitcnt lgkmcnt(1)
    v_dot2_f32_bf16 v48, v176, v40, 0
    v_dot2_f32_bf16 v49, v84, v40, 0
    v_dot2_f32_bf16 v50, v80, v40, 0
    v_dot2_f32_bf16 v51, v85, v40, 0
    v_dot2_f32_bf16 v52, v81, v40, 0
    v_dot2_f32_bf16 v53, v86, v40, 0
    v_dot2_f32_bf16 v54, v82, v40, 0
    v_dot2_f32_bf16 v55, v87, v40, 0
    v_dot2c_f32_bf16 v48, v83, v41
    v_dot2c_f32_bf16 v49, v92, v41
    v_dot2c_f32_bf16 v50, v88, v41
    v_dot2c_f32_bf16 v51, v93, v41
    v_dot2c_f32_bf16 v52, v89, v41
    v_dot2c_f32_bf16 v53, v94, v41
    v_dot2c_f32_bf16 v54, v90, v41
    v_dot2c_f32_bf16 v55, v95, v41
    v_dot2c_f32_bf16 v48, v91, v42
    v_dot2c_f32_bf16 v49, v100, v42
    v_dot2c_f32_bf16 v50, v96, v42
    v_dot2c_f32_bf16 v51, v101, v42
    v_dot2c_f32_bf16 v52, v97, v42
    v_dot2c_f32_bf16 v53, v102, v42
    v_dot2c_f32_bf16 v54, v98, v42
    v_dot2c_f32_bf16 v55, v103, v42
    v_dot2c_f32_bf16 v48, v99, v43
    v_dot2c_f32_bf16 v49, v108, v43
    v_dot2c_f32_bf16 v50, v104, v43
    v_dot2c_f32_bf16 v51, v109, v43
    v_dot2c_f32_bf16 v52, v105, v43
    v_dot2c_f32_bf16 v53, v110, v43
    v_dot2c_f32_bf16 v54, v106, v43
    v_dot2c_f32_bf16 v55, v111, v43
    s_waitcnt lgkmcnt(0)
    v_dot2c_f32_bf16 v48, v107, v44
    v_dot2c_f32_bf16 v49, v116, v44
    v_dot2c_f32_bf16 v50, v112, v44
    v_dot2c_f32_bf16 v51, v117, v44
    v_dot2c_f32_bf16 v52, v113, v44
    v_dot2c_f32_bf16 v53, v118, v44
    v_dot2c_f32_bf16 v54, v114, v44
    v_dot2c_f32_bf16 v55, v119, v44
    v_dot2c_f32_bf16 v48, v115, v45
    v_dot2c_f32_bf16 v49, v124, v45
    v_dot2c_f32_bf16 v50, v120, v45
    v_dot2c_f32_bf16 v51, v125, v45
    v_dot2c_f32_bf16 v52, v121, v45
    v_dot2c_f32_bf16 v53, v126, v45
    v_dot2c_f32_bf16 v54, v122, v45
    v_dot2c_f32_bf16 v55, v127, v45
    v_dot2c_f32_bf16 v48, v123, v46
    v_dot2c_f32_bf16 v49, v132, v46
    v_dot2c_f32_bf16 v50, v128, v46
    v_dot2c_f32_bf16 v51, v133, v46
    v_dot2c_f32_bf16 v52, v129, v46
    v_dot2c_f32_bf16 v53, v134, v46
    v_dot2c_f32_bf16 v54, v130, v46
    v_dot2c_f32_bf16 v55, v135, v46
    v_dot2c_f32_bf16 v48, v131, v47
    v_dot2c_f32_bf16 v49, v140, v47
    v_dot2c_f32_bf16 v50, v136, v47
    v_dot2c_f32_bf16 v51, v141, v47
    v_dot2c_f32_bf16 v52, v137, v47
    v_dot2c_f32_bf16 v53, v142, v47
    v_dot2c_f32_bf16 v54, v138, v47
    v_dot2c_f32_bf16 v55, v143, v47
    v_permlane32_swap_b32 v48, v52
    v_permlane32_swap_b32 v49, v53
    v_permlane32_swap_b32 v50, v54
    v_permlane32_swap_b32 v51, v55
    v_add_f32 v48, v48, v52
    v_add_f32 v49, v49, v53
    v_add_f32 v50, v50, v54
    v_add_f32 v51, v51, v55
    v_mov_b32 v52, v48
    v_mov_b32 v53, v49
    v_mov_b32 v54, v50
    v_mov_b32 v55, v51
    v_permlane16_swap_b32 v52, v48
    v_permlane16_swap_b32 v53, v49
    v_permlane16_swap_b32 v54, v50
    v_permlane16_swap_b32 v55, v51
    v_add_f32 v48, v48, v52
    v_add_f32 v49, v49, v53
    v_add_f32 v50, v50, v54
    v_add_f32 v51, v51, v55
    v_add_f32_dpp v48, v48, v48 row_ror:8 row_mask:0xf bank_mask:0xf
    v_add_f32_dpp v49, v49, v49 row_ror:8 row_mask:0xf bank_mask:0xf
    v_add_f32_dpp v50, v50, v50 row_ror:8 row_mask:0xf bank_mask:0xf
    v_add_f32_dpp v51, v51, v51 row_ror:8 row_mask:0xf bank_mask:0xf
    v_add_f32_dpp v48, v48, v48 row_ror:4 row_mask:0xf bank_mask:0xf
    v_add_f32_dpp v49, v49, v49 row_ror:4 row_mask:0xf bank_mask:0xf
    v_add_f32_dpp v50, v50, v50 row_ror:4 row_mask:0xf bank_mask:0xf
    v_add_f32_dpp v51, v51, v51 row_ror:4 row_mask:0xf bank_mask:0xf
    v_bfi_b32 v48, s68, v23, v48
    v_bfi_b32 v49, s68, v23, v49
    v_bfi_b32 v50, s68, v23, v50
    v_bfi_b32 v51, s68, v23, v51
    s_and_b32 exec_lo, s90, 0xf
    s_and_b32 exec_hi, s91, 0xf
    s_cmp_eq_u32 s90, 0
    s_cbranch_scc1 L_nost_9
    buffer_store_dwordx4 v[48:51], v70, s[16:19], s46 offen sc1
L_nost_9:
    s_mov_b64 exec, s[90:91]
    s_branch L_exit
L_role_ffn:
    s_cmp_eq_u32 s90, 0
    s_cbranch_scc1 L_nw_10
    s_waitcnt vmcnt(0)
L_nw_10:
    s_mov_b32 s28, 0x05040100
    s_mov_b32 s29, 0x07060302
    v_perm_b32 v176, v84, v80, s28
    v_perm_b32 v84, v84, v80, s29
    v_perm_b32 v80, v85, v81, s28
    v_perm_b32 v85, v85, v81, s29
    v_perm_b32 v81, v86, v82, s28
    v_perm_b32 v86, v86, v82, s29
    v_perm_b32 v82, v87, v83, s28
    v_perm_b32 v87, v87, v83, s29
    v_perm_b32 v83, v92, v88, s28
    v_perm_b32 v92, v92, v88, s29
    v_perm_b32 v88, v93, v89, s28
    v_perm_b32 v93, v93, v89, s29
    v_perm_b32 v89, v94, v90, s28
    v_perm_b32 v94, v94, v90, s29
    v_perm_b32 v90, v95, v91, s28
    v_perm_b32 v95, v95, v91, s29
    v_perm_b32 v91, v100, v96, s28
    v_perm_b32 v100, v100, v96, s29
    v_perm_b32 v96, v101, v97, s28
    v_perm_b32 v101, v101, v97, s29
    v_perm_b32 v97, v102, v98, s28
    v_perm_b32 v102, v102, v98, s29
    v_perm_b32 v98, v103, v99, s28
    v_perm_b32 v103, v103, v99, s29
    v_perm_b32 v99, v108, v104, s28
    v_perm_b32 v108, v108, v104, s29
    v_perm_b32 v104, v109, v105, s28
    v_perm_b32 v109, v109, v105, s29
    v_perm_b32 v105, v110, v106, s28
    v_perm_b32 v110, v110, v106, s29
    v_perm_b32 v106, v111, v107, s28
    v_perm_b32 v111, v111, v107, s29
    v_perm_b32 v107, v116, v112, s28
    v_perm_b32 v116, v116, v112, s29
    v_perm_b32 v112, v117, v113, s28
    v_perm_b32 v117, v117, v113, s29
    v_perm_b32 v113, v118, v114, s28
    v_perm_b32 v118, v118, v114, s29
    v_perm_b32 v114, v119, v115, s28
    v_perm_b32 v119, v119, v115, s29
    v_perm_b32 v115, v124, v120, s28
    v_perm_b32 v124, v124, v120, s29
    v_perm_b32 v120, v125, v121, s28
    v_perm_b32 v125, v125, v121, s29
    v_perm_b32 v121, v126, v122, s28
    v_perm_b32 v126, v126, v122, s29
    v_perm_b32 v122, v127, v123, s28
    v_perm_b32 v127, v127, v123, s29
    v_perm_b32 v123, v132, v128, s28
    v_perm_b32 v132, v132, v128, s29
    v_perm_b32 v128, v133, v129, s28
    v_perm_b32 v133, v133, v129, s29
    v_perm_b32 v129, v134, v130, s28
    v_perm_b32 v134, v134, v130, s29
    v_perm_b32 v130, v135, v131, s28
    v_perm_b32 v135, v135, v131, s29
    v_perm_b32 v131, v140, v136, s28
    v_perm_b32 v140, v140, v136, s29
    v_perm_b32 v136, v141, v137, s28
    v_perm_b32 v141, v141, v137, s29
    v_perm_b32 v137, v142, v138, s28
    v_perm_b32 v142, v142, v138, s29
    v_perm_b32 v138, v143, v139, s28
    v_perm_b32 v143, v143, v139, s29
    v_perm_b32 v139, v148, v144, s28
    v_perm_b32 v148, v148, v144, s29
    v_perm_b32 v144, v149, v145, s28
    v_perm_b32 v149, v149, v145, s29
    v_perm_b32 v145, v150, v146, s28
    v_perm_b32 v150, v150, v146, s29
    v_perm_b32 v146, v151, v147, s28
    v_perm_b32 v151, v151, v147, s29
    v_perm_b32 v147, v156, v152, s28
    v_perm_b32 v156, v156, v152, s29
    v_perm_b32 v152, v157, v153, s28
    v_perm_b32 v157, v157, v153, s29
    v_perm_b32 v153, v158, v154, s28
    v_perm_b32 v158, v158, v154, s29
    v_perm_b32 v154, v159, v155, s28
    v_perm_b32 v159, v159, v155, s29
    v_perm_b32 v155, v164, v160, s28
    v_perm_b32 v164, v164, v160, s29
    v_perm_b32 v160, v165, v161, s28
    v_perm_b32 v165, v165, v161, s29
    v_perm_b32 v161, v166, v162, s28
    v_perm_b32 v166, v166, v162, s29
    v_perm_b32 v162, v167, v163, s28
    v_perm_b32 v167, v167, v163, s29
    v_perm_b32 v163, v172, v168, s28
    v_perm_b32 v172, v172, v168, s29
    v_perm_b32 v168, v173, v169, s28
    v_perm_b32 v173, v173, v169, s29
    v_perm_b32 v169, v174, v170, s28
    v_perm_b32 v174, v174, v170, s29
    v_perm_b32 v170, v175, v171, s28
    v_perm_b32 v175, v175, v171, s29
    s_lshl_b32 s30, s3, 2
    v_lshrrev_b32 v72, 5, v0
    v_lshlrev_b32 v73, 4, v72
    v_add_u32 v73, s30, v73
    v_lshlrev_b32 v72, 9, v72
    v_and_b32 v57, 3, v0
    v_lshl_add_u32 v72, v57, 7, v72
    v_bfe_u32 v57, v0, 4, 1
    v_lshl_add_u32 v72, v57, 6, v72
    v_add_u32 v72, s30, v72
    v_and_b32 v56, 31, v0
    v_lshlrev_b32 v66, 4, v56
    v_mov_b32 v40, 0x3f803f80
    v_mov_b32 v41, 0x3f803f80
    v_mov_b32 v42, 0x3f803f80
    v_mov_b32 v43, 0x3f803f80
    v_mov_b32 v250, 0x3f803f80
    v_mov_b32 v251, 0
    v_dot2_f32_bf16 v60, v40, v250, 0
    v_dot2_f32_bf16 v61, v40, v40, 0
    v_dot2_f32_bf16 v24, v176, v40, 0
    v_dot2_f32_bf16 v32, v107, v40, 0
    v_dot2_f32_bf16 v25, v84, v40, 0
    v_dot2_f32_bf16 v33, v116, v40, 0
    v_dot2_f32_bf16 v26, v80, v40, 0
    v_dot2_f32_bf16 v34, v112, v40, 0
    v_dot2_f32_bf16 v27, v85, v40, 0
    v_dot2_f32_bf16 v35, v117, v40, 0
    v_dot2_f32_bf16 v28, v81, v40, 0
    v_dot2_f32_bf16 v36, v113, v40, 0
    v_dot2_f32_bf16 v29, v86, v40, 0
    v_dot2_f32_bf16 v37, v118, v40, 0
    v_dot2_f32_bf16 v30, v82, v40, 0
    v_dot2_f32_bf16 v38, v114, v40, 0
    v_dot2_f32_bf16 v31, v87, v40, 0
    v_dot2_f32_bf16 v39, v119, v40, 0
    v_dot2c_f32_bf16 v60, v41, v250
    v_dot2c_f32_bf16 v61, v41, v41
    v_dot2c_f32_bf16 v24, v83, v41
    v_dot2c_f32_bf16 v32, v115, v41
    v_dot2c_f32_bf16 v25, v92, v41
    v_dot2c_f32_bf16 v33, v124, v41
    v_dot2c_f32_bf16 v26, v88, v41
    v_dot2c_f32_bf16 v34, v120, v41
    v_dot2c_f32_bf16 v27, v93, v41
    v_dot2c_f32_bf16 v35, v125, v41
    v_dot2c_f32_bf16 v28, v89, v41
    v_dot2c_f32_bf16 v36, v121, v41
    v_dot2c_f32_bf16 v29, v94, v41
    v_dot2c_f32_bf16 v37, v126, v41
    v_dot2c_f32_bf16 v30, v90, v41
    v_dot2c_f32_bf16 v38, v122, v41
    v_dot2c_f32_bf16 v31, v95, v41
    v_dot2c_f32_bf16 v39, v127, v41
    v_dot2c_f32_bf16 v60, v42, v250
    v_dot2c_f32_bf16 v61, v42, v42
    v_dot2c_f32_bf16 v24, v91, v42
    v_dot2c_f32_bf16 v32, v123, v42
    v_dot2c_f32_bf16 v25, v100, v42
    v_dot2c_f32_bf16 v33, v132, v42
    v_dot2c_f32_bf16 v26, v96, v42
    v_dot2c_f32_bf16 v34, v128, v42
    v_dot2c_f32_bf16 v27, v101, v42
    v_dot2c_f32_bf16 v35, v133, v42
    v_dot2c_f32_bf16 v28, v97, v42
    v_dot2c_f32_bf16 v36, v129, v42
    v_dot2c_f32_bf16 v29, v102, v42
    v_dot2c_f32_bf16 v37, v134, v42
    v_dot2c_f32_bf16 v30, v98, v42
    v_dot2c_f32_bf16 v38, v130, v42
    v_dot2c_f32_bf16 v31, v103, v42
    v_dot2c_f32_bf16 v39, v135, v42
    v_dot2c_f32_bf16 v60, v43, v250
    v_dot2c_f32_bf16 v61, v43, v43
    v_dot2c_f32_bf16 v24, v99, v43
    v_dot2c_f32_bf16 v32, v131, v43
    v_dot2c_f32_bf16 v25, v108, v43
    v_dot2c_f32_bf16 v33, v140, v43
    v_dot2c_f32_bf16 v26, v104, v43
    v_dot2c_f32_bf16 v34, v136, v43
    v_dot2c_f32_bf16 v27, v109, v43
    v_dot2c_f32_bf16 v35, v141, v43
    v_dot2c_f32_bf16 v28, v105, v43
    v_dot2c_f32_bf16 v36, v137, v43
    v_dot2c_f32_bf16 v29, v110, v43
    v_dot2c_f32_bf16 v37, v142, v43
    v_dot2c_f32_bf16 v30, v106, v43
    v_dot2c_f32_bf16 v38, v138, v43
    v_dot2c_f32_bf16 v31, v111, v43
    v_dot2c_f32_bf16 v39, v143, v43
    v_permlane32_swap_b32 v24, v32
    v_permlane32_swap_b32 v25, v33
    v_permlane32_swap_b32 v26, v34
    v_permlane32_swap_b32 v27, v35
    v_permlane32_swap_b32 v28, v36
    v_permlane32_swap_b32 v29, v37
    v_permlane32_swap_b32 v30, v38
    v_permlane32_swap_b32 v31, v39
    v_permlane32_swap_b32 v60, v61
    v_add_f32 v24, v24, v32
    v_add_f32 v25, v25, v33
    v_add_f32 v26, v26, v34
    v_add_f32 v27, v27, v35
    v_add_f32 v28, v28, v36
    v_add_f32 v29, v29, v37
    v_add_f32 v30, v30, v38
    v_add_f32 v31, v31, v39
    v_add_f32 v60, v60, v61
    v_permlane16_swap_b32 v24, v28
    v_permlane16_swap_b32 v25, v29
    v_permlane16_swap_b32 v26, v30
    v_permlane16_swap_b32 v27, v31
    v_mov_b32 v61, v60
    v_add_f32 v24, v24, v28
    v_add_f32 v25, v25, v29
    v_add_f32 v26, v26, v30
    v_add_f32 v27, v27, v31
    v_permlane16_swap_b32 v61, v60
    v_add_f32 v60, v60, v61
    v_add_f32_dpp v24, v24, v24 row_ror:8 row_mask:0xf bank_mask:0xf
    v_add_f32_dpp v25, v25, v25 row_ror:8 row_mask:0xf bank_mask:0xf
    v_add_f32_dpp v26, v26, v26 row_ror:8 row_mask:0xf bank_mask:0xf
    v_add_f32_dpp v27, v27, v27 row_ror:8 row_mask:0xf bank_mask:0xf
    v_add_f32_dpp v60, v60, v60 row_ror:8 row_mask:0xf bank_mask:0xf
    v_add_f32_dpp v24, v24, v24 row_ror:4 row_mask:0xf bank_mask:0xf
    v_add_f32_dpp v25, v25, v25 row_ror:4 row_mask:0xf bank_mask:0xf
    v_add_f32_dpp v26, v26, v26 row_ror:4 row_mask:0xf bank_mask:0xf
    v_add_f32_dpp v27, v27, v27 row_ror:4 row_mask:0xf bank_mask:0xf
    v_add_f32_dpp v60, v60, v60 row_ror:4 row_mask:0xf bank_mask:0xf
    s_and_b32 exec_lo, s90, 0xf000f
    s_and_b32 exec_hi, s91, 0xf000f
    ds_write_b32 v72, v24 offset:12800
    ds_write_b32 v72, v25 offset:12816
    ds_write_b32 v72, v26 offset:12832
    ds_write_b32 v72, v27 offset:12848
    s_and_b32 exec_lo, s90, 0x1
    s_and_b32 exec_hi, s91, 0x1
    ds_write_b32 v73, v60 offset:13824
    s_mov_b64 exec, s[90:91]
    s_waitcnt lgkmcnt(0)
    s_cmp_eq_u32 s90, 0
    s_cbranch_scc1 L_nobar_11
    s_barrier
L_nobar_11:
    ds_read_b128 v[24:27], v66 offset:12800
    ds_read_b128 v[28:31], v66 offset:13312
    s_waitcnt lgkmcnt(0)
    v_add_f32 v24, v24, v25
    v_add_f32 v26, v26, v27
    v_add_f32 v70, v24, v26
    v_add_f32 v28, v28, v29
    v_add_f32 v30, v30, v31
    v_add_f32 v71, v28, v30
    s_cmp_eq_u32 s90, 0
    s_cbranch_scc1 L_nobar_12
    s_barrier
L_nobar_12:
    s_mov_b32 s20, s36
    s_and_b32 s21, s37, 0xffff
    s_mov_b32 s22, 0x400
    s_mov_b32 s23, 0x20000
    v_and_b32 v56, 31, v0
    v_lshrrev_b32 v57, 5, v0
    v_lshlrev_b32 v64, 14, v57
    v_lshl_add_u32 v64, v56, 4, v64
    s_lshl_b32 s33, s3, 9
    s_add_u32 s33, s33, 851968
    v_lshlrev_b32 v65, 3, v56
    v_lshl_add_u32 v65, v57, 2, v65
    s_lshl_b32 s30, s3, 8
    v_add_u32 v58, s30, v65
    s_cmp_eq_u32 s90, 0
    s_cbranch_scc1 L_nost_13
    buffer_load_dword v68, v58, s[20:23], 0 offen
L_nost_13:
    v_add_u32 v65, s30, v65
    v_lshrrev_b32 v74, 2, v0
    v_lshlrev_b32 v74, 4, v74
    v_add_u32 v74, s30, v74
    v_and_b32 v75, 31, v0
    v_lshlrev_b32 v75, 1, v75
    s_lshl_b32 s31, s3, 6
    v_add_u32 v75, s31, v75
    v_lshrrev_b32 v76, 4, v0
    v_lshlrev_b32 v76, 4, v76
    v_add_u32 v76, s31, v76
    v_and_b32 v77, 15, v0
    v_lshlrev_b32 v77, 1, v77
    v_lshrrev_b32 v57, 5, v0
    v_add_u32 v77, v77, v57
    v_lshlrev_b32 v78, 3, v77
    v_add_u32 v78, s30, v78
    s_lshl_b32 s31, s3, 5
    v_add_u32 v77, s31, v77
    v_lshlrev_b32 v77, 4, v77
    s_lshl_b32 s46, s69, 11
    s_add_u32 s46, s46, 917504
    s_mov_b32 s62, 200000
L_poll_B:
    s_cmp_eq_u32 s90, 0
    s_cbranch_scc1 L_dryld_14
    s_add_u32 s35, s33, 0
    buffer_load_dwordx4 v[180:183], v64, s[16:19], s35 offen offset:0 sc1
    buffer_load_dwordx4 v[184:187], v64, s[16:19], s35 offen offset:2048 sc1
    s_add_u32 s35, s33, 4096
    buffer_load_dwordx4 v[188:191], v64, s[16:19], s35 offen offset:0 sc1
    buffer_load_dwordx4 v[192:195], v64, s[16:19], s35 offen offset:2048 sc1
    s_add_u32 s35, s33, 8192
    buffer_load_dwordx4 v[196:199], v64, s[16:19], s35 offen offset:0 sc1
    buffer_load_dwordx4 v[200:203], v64, s[16:19], s35 offen offset:2048 sc1
    s_add_u32 s35, s33, 12288
    buffer_load_dwordx4 v[204:207], v64, s[16:19], s35 offen offset:0 sc1
    buffer_load_dwordx4 v[208:211], v64, s[16:19], s35 offen offset:2048 sc1
L_dryld_14:
    s_waitcnt vmcnt(7)
    v_xor_b32 v79, v180, v23
    v_bitop3_b32 v79, v181, v23, v79 bitop3:0xBE
    v_bitop3_b32 v79, v182, v23, v79 bitop3:0xBE
    v_bitop3_b32 v79, v183, v23, v79 bitop3:0xBE
    s_waitcnt vmcnt(6)
    v_bitop3_b32 v79, v184, v23, v79 bitop3:0xBE
    v_bitop3_b32 v79, v185, v23, v79 bitop3:0xBE
    v_bitop3_b32 v79, v186, v23, v79 bitop3:0xBE
    v_bitop3_b32 v79, v187, v23, v79 bitop3:0xBE
    v_add_f32 v24, v180, v184
    v_add_f32 v25, v181, v185
    v_add_f32 v26, v182, v186
    v_add_f32 v27, v183, v187
    s_waitcnt vmcnt(5)
    v_bitop3_b32 v79, v188, v23, v79 bitop3:0xBE
    v_bitop3_b32 v79, v189, v23, v79 bitop3:0xBE
    v_bitop3_b32 v79, v190, v23, v79 bitop3:0xBE
    v_bitop3_b32 v79, v191, v23, v79 bitop3:0xBE
    v_add_f32 v24, v24, v188
    v_add_f32 v25, v25, v189
    v_add_f32 v26, v26, v190
    v_add_f32 v27, v27, v191
    s_waitcnt vmcnt(4)
    v_bitop3_b32 v79, v192, v23, v79 bitop3:0xBE
    v_bitop3_b32 v79, v193, v23, v79 bitop3:0xBE
    v_bitop3_b32 v79, v194, v23, v79 bitop3:0xBE
    v_bitop3_b32 v79, v195, v23, v79 bitop3:0xBE
    v_add_f32 v24, v24, v192
    v_add_f32 v25, v25, v193
    v_add_f32 v26, v26, v194
    v_add_f32 v27, v27, v195
    s_waitcnt vmcnt(3)
    v_bitop3_b32 v79, v196, v23, v79 bitop3:0xBE
    v_bitop3_b32 v79, v197, v23, v79 bitop3:0xBE
    v_bitop3_b32 v79, v198, v23, v79 bitop3:0xBE
    v_bitop3_b32 v79, v199, v23, v79 bitop3:0xBE
    v_add_f32 v24, v24, v196
    v_add_f32 v25, v25, v197
    v_add_f32 v26, v26, v198
    v_add_f32 v27, v27, v199
    s_waitcnt vmcnt(2)
    v_bitop3_b32 v79, v200, v23, v79 bitop3:0xBE
    v_bitop3_b32 v79, v201, v23, v79 bitop3:0xBE
    v_bitop3_b32 v79, v202, v23, v79 bitop3:0xBE
    v_bitop3_b32 v79, v203, v23, v79 bitop3:0xBE
    v_add_f32 v24, v24, v200
    v_add_f32 v25, v25, v201
    v_add_f32 v26, v26, v202
    v_add_f32 v27, v27, v203
    s_waitcnt vmcnt(1)
    v_bitop3_b32 v79, v204, v23, v79 bitop3:0xBE
    v_bitop3_b32 v79, v205, v23, v79 bitop3:0xBE
    v_bitop3_b32 v79, v206, v23, v79 bitop3:0xBE
    v_bitop3_b32 v79, v207, v23, v79 bitop3:0xBE
    v_add_f32 v24, v24, v204
    v_add_f32 v25, v25, v205
    v_add_f32 v26, v26, v206
    v_add_f32 v27, v27, v207
    s_waitcnt vmcnt(0)
    v_bitop3_b32 v79, v208, v23, v79 bitop3:0xBE
    v_bitop3_b32 v79, v209, v23, v79 bitop3:0xBE
    v_bitop3_b32 v79, v210, v23, v79 bitop3:0xBE
    v_bitop3_b32 v79, v211, v23, v79 bitop3:0xBE
    v_add_f32 v24, v24, v208
    v_add_f32 v25, v25, v209
    v_add_f32 v26, v26, v210
    v_add_f32 v27, v27, v211
    v_and_b32 v79, 0xfff, v79
    v_cmp_ne_u32 vcc, 0, v79
    s_cbranch_vccz L_pollok_B
L_pollretry_B:
    s_sub_u32 s62, s62, 1
    s_cmp_eq_u32 s62, 0
    s_cbranch_scc0 L_poll_B
L_pollok_B:
    v_permlane32_swap_b32 v24, v26
    v_permlane32_swap_b32 v25, v27
    v_lshlrev_b32 v56, 16, v68
    v_and_b32 v57, 0xffff0000, v68
    v_add_f32 v24, v24, v26
    v_add_f32 v25, v25, v27
    v_cvt_pk_bf16_f32 v58, v24, v25
    v_lshlrev_b32 v24, 16, v58
    v_and_b32 v25, 0xffff0000, v58
    v_add_f32 v24, v24, v56
    v_add_f32 v25, v25, v57
    v_cvt_pk_bf16_f32 v58, v24, v25
    ds_write_b32 v65, v58 offset:10752
    s_waitcnt lgkmcnt(0)
    ds_read_b128 v[40:43], v74 offset:10752
    ds_read_b64 v[212:213], v78 offset:10752
    s_waitcnt lgkmcnt(1)
    v_dot2_f32_bf16 v60, v40, v250, 0
    v_dot2_f32_bf16 v61, v40, v40, 0
    v_dot2_f32_bf16 v24, v176, v40, 0
    v_dot2_f32_bf16 v32, v107, v40, 0
    v_dot2_f32_bf16 v25, v84, v40, 0
    v_dot2_f32_bf16 v33, v116, v40, 0
    v_dot2_f32_bf16 v26, v80, v40, 0
    v_dot2_f32_bf16 v34, v112, v40, 0
    v_dot2_f32_bf16 v27, v85, v40, 0
    v_dot2_f32_bf16 v35, v117, v40, 0
    v_dot2_f32_bf16 v28, v81, v40, 0
    v_dot2_f32_bf16 v36, v113, v40, 0
    v_dot2_f32_bf16 v29, v86, v40, 0
    v_dot2_f32_bf16 v37, v118, v40, 0
    v_dot2_f32_bf16 v30, v82, v40, 0
    v_dot2_f32_bf16 v38, v114, v40, 0
    v_dot2_f32_bf16 v31, v87, v40, 0
    v_dot2_f32_bf16 v39, v119, v40, 0
    v_dot2c_f32_bf16 v60, v41, v250
    v_dot2c_f32_bf16 v61, v41, v41
    v_dot2c_f32_bf16 v24, v83, v41
    v_dot2c_f32_bf16 v32, v115, v41
    v_dot2c_f32_bf16 v25, v92, v41
    v_dot2c_f32_bf16 v33, v124, v41
    v_dot2c_f32_bf16 v26, v88, v41
    v_dot2c_f32_bf16 v34, v120, v41
    v_dot2c_f32_bf16 v27, v93, v41
    v_dot2c_f32_bf16 v35, v125, v41
    v_dot2c_f32_bf16 v28, v89, v41
    v_dot2c_f32_bf16 v36, v121, v41
    v_dot2c_f32_bf16 v29, v94, v41
    v_dot2c_f32_bf16 v37, v126, v41
    v_dot2c_f32_bf16 v30, v90, v41
    v_dot2c_f32_bf16 v38, v122, v41
    v_dot2c_f32_bf16 v31, v95, v41
    v_dot2c_f32_bf16 v39, v127, v41
    v_dot2c_f32_bf16 v60, v42, v250
    v_dot2c_f32_bf16 v61, v42, v42
    v_dot2c_f32_bf16 v24, v91, v42
    v_dot2c_f32_bf16 v32, v123, v42
    v_dot2c_f32_bf16 v25, v100, v42
    v_dot2c_f32_bf16 v33, v132, v42
    v_dot2c_f32_bf16 v26, v96, v42
    v_dot2c_f32_bf16 v34, v128, v42
    v_dot2c_f32_bf16 v27, v101, v42
    v_dot2c_f32_bf16 v35, v133, v42
    v_dot2c_f32_bf16 v28, v97, v42
    v_dot2c_f32_bf16 v36, v129, v42
    v_dot2c_f32_bf16 v29, v102, v42
    v_dot2c_f32_bf16 v37, v134, v42
    v_dot2c_f32_bf16 v30, v98, v42
    v_dot2c_f32_bf16 v38, v130, v42
    v_dot2c_f32_bf16 v31, v103, v42
    v_dot2c_f32_bf16 v39, v135, v42
    v_dot2c_f32_bf16 v60, v43, v250
    v_dot2c_f32_bf16 v61, v43, v43
    v_dot2c_f32_bf16 v24, v99, v43
    v_dot2c_f32_bf16 v32, v131, v43
    v_dot2c_f32_bf16 v25, v108, v43
    v_dot2c_f32_bf16 v33, v140, v43
    v_dot2c_f32_bf16 v26, v104, v43
    v_dot2c_f32_bf16 v34, v136, v43
    v_dot2c_f32_bf16 v27, v109, v43
    v_dot2c_f32_bf16 v35, v141, v43
    v_dot2c_f32_bf16 v28, v105, v43
    v_dot2c_f32_bf16 v36, v137, v43
    v_dot2c_f32_bf16 v29, v110, v43
    v_dot2c_f32_bf16 v37, v142, v43
    v_dot2c_f32_bf16 v30, v106, v43
    v_dot2c_f32_bf16 v38, v138, v43
    v_dot2c_f32_bf16 v31, v111, v43
    v_dot2c_f32_bf16 v39, v143, v43
    v_permlane32_swap_b32 v24, v32
    v_permlane32_swap_b32 v25, v33
    v_permlane32_swap_b32 v26, v34
    v_permlane32_swap_b32 v27, v35
    v_permlane32_swap_b32 v28, v36
    v_permlane32_swap_b32 v29, v37
    v_permlane32_swap_b32 v30, v38
    v_permlane32_swap_b32 v31, v39
    v_permlane32_swap_b32 v60, v61
    v_add_f32 v24, v24, v32
    v_add_f32 v25, v25, v33
    v_add_f32 v26, v26, v34
    v_add_f32 v27, v27, v35
    v_add_f32 v28, v28, v36
    v_add_f32 v29, v29, v37
    v_add_f32 v30, v30, v38
    v_add_f32 v31, v31, v39
    v_add_f32 v60, v60, v61
    v_permlane16_swap_b32 v24, v28
    v_permlane16_swap_b32 v25, v29
    v_permlane16_swap_b32 v26, v30
    v_permlane16_swap_b32 v27, v31
    v_mov_b32 v61, v60
    v_add_f32 v24, v24, v28
    v_add_f32 v25, v25, v29
    v_add_f32 v26, v26, v30
    v_add_f32 v27, v27, v31
    v_permlane16_swap_b32 v61, v60
    v_add_f32 v60, v60, v61
    v_add_f32_dpp v24, v24, v24 row_ror:8 row_mask:0xf bank_mask:0xf
    v_add_f32_dpp v25, v25, v25 row_ror:8 row_mask:0xf bank_mask:0xf
    v_add_f32_dpp v26, v26, v26 row_ror:8 row_mask:0xf bank_mask:0xf
    v_add_f32_dpp v27, v27, v27 row_ror:8 row_mask:0xf bank_mask:0xf
    v_add_f32_dpp v60, v60, v60 row_ror:8 row_mask:0xf bank_mask:0xf
    v_add_f32_dpp v24, v24, v24 row_ror:4 row_mask:0xf bank_mask:0xf
    v_add_f32_dpp v25, v25, v25 row_ror:4 row_mask:0xf bank_mask:0xf
    v_add_f32_dpp v26, v26, v26 row_ror:4 row_mask:0xf bank_mask:0xf
    v_add_f32_dpp v27, v27, v27 row_ror:4 row_mask:0xf bank_mask:0xf
    v_add_f32_dpp v60, v60, v60 row_ror:4 row_mask:0xf bank_mask:0xf
    s_and_b32 exec_lo, s90, 0xf000f
    s_and_b32 exec_hi, s91, 0xf000f
    ds_write_b32 v72, v24 offset:12800
    ds_write_b32 v72, v25 offset:12816
    ds_write_b32 v72, v26 offset:12832
    ds_write_b32 v72, v27 offset:12848
    s_and_b32 exec_lo, s90, 0x1
    s_and_b32 exec_hi, s91, 0x1
    ds_write_b32 v73, v60 offset:13824
    s_mov_b64 exec, s[90:91]
    s_waitcnt lgkmcnt(0)
    s_cmp_eq_u32 s90, 0
    s_cbranch_scc1 L_nobar_15
    s_barrier
L_nobar_15:
    ds_read_b128 v[24:27], v66 offset:12800
    ds_read_b128 v[28:31], v66 offset:13312
    ds_read_b128 v[32:35], v251 offset:13824
    ds_read_b128 v[36:39], v251 offset:13840
    s_waitcnt lgkmcnt(0)
    v_add_f32 v24, v24, v25
    v_add_f32 v26, v26, v27
    v_add_f32 v28, v28, v29
    v_add_f32 v30, v30, v31
    v_add_f32 v32, v32, v33
    v_add_f32 v34, v34, v35
    v_add_f32 v36, v36, v37
    v_add_f32 v38, v38, v39
    v_add_f32 v24, v24, v26
    v_add_f32 v28, v28, v30
    v_add_f32 v32, v32, v34
    v_add_f32 v36, v36, v38
    v_mul_f32 v32, 0x3b000000, v32
    v_mul_f32 v36, 0x3b000000, v36
    v_fma_f32 v36, -v32, v32, v36
    v_add_f32 v36, 0x3727c5ac, v36
    v_rsq_f32 v36, v36
    v_fma_f32 v24, -v32, v70, v24
    v_fma_f32 v25, -v32, v71, v28
    v_mul_f32 v24, v24, v36
    v_mul_f32 v25, v25, v36
    v_cvt_pk_bf16_f32 v28, v24, v25
    v_lshlrev_b32 v24, 16, v28
    v_and_b32 v25, 0xffff0000, v28
    v_mul_f32 v29, v24, v24
    v_mul_f32 v29, 0x3d372713, v29
    v_add_f32 v29, 1.0, v29
    v_mul_f32 v29, v29, v24
    v_mul_f32 v29, 0xc0135761, v29
    v_exp_f32 v29, v29
    s_nop 0
    v_add_f32 v29, 1.0, v29
    v_rcp_f32 v29, v29
    s_nop 0
    v_mul_f32 v29, v29, v24
    v_cvt_pk_bf16_f32 v29, v29, v29
    v_and_b32 v29, 0xffff0000, v29
    v_mul_f32 v29, v29, v25
    v_cvt_pk_bf16_f32 v29, v29, v29
    ds_write_b16 v75, v29 offset:14080
    v_lshlrev_b32 v214, 16, v213
    v_and_b32 v215, 0xffff0000, v213
    v_and_b32 v213, 0xffff0000, v212
    v_lshlrev_b32 v212, 16, v212
    s_waitcnt lgkmcnt(0)
    ds_read_b128 v[40:43], v76 offset:14080
    s_waitcnt lgkmcnt(0)
    v_dot2_f32_bf16 v48, v139, v40, 0
    v_dot2_f32_bf16 v49, v148, v40, 0
    v_dot2_f32_bf16 v50, v144, v40, 0
    v_dot2_f32_bf16 v51, v149, v40, 0
    v_dot2_f32_bf16 v52, v145, v40, 0
    v_dot2_f32_bf16 v53, v150, v40, 0
    v_dot2_f32_bf16 v54, v146, v40, 0
    v_dot2_f32_bf16 v55, v151, v40, 0
    v_dot2c_f32_bf16 v48, v147, v41
    v_dot2c_f32_bf16 v49, v156, v41
    v_dot2c_f32_bf16 v50, v152, v41
    v_dot2c_f32_bf16 v51, v157, v41
    v_dot2c_f32_bf16 v52, v153, v41
    v_dot2c_f32_bf16 v53, v158, v41
    v_dot2c_f32_bf16 v54, v154, v41
    v_dot2c_f32_bf16 v55, v159, v41
    v_dot2c_f32_bf16 v48, v155, v42
    v_dot2c_f32_bf16 v49, v164, v42
    v_dot2c_f32_bf16 v50, v160, v42
    v_dot2c_f32_bf16 v51, v165, v42
    v_dot2c_f32_bf16 v52, v161, v42
    v_dot2c_f32_bf16 v53, v166, v42
    v_dot2c_f32_bf16 v54, v162, v42
    v_dot2c_f32_bf16 v55, v167, v42
    v_dot2c_f32_bf16 v48, v163, v43
    v_dot2c_f32_bf16 v49, v172, v43
    v_dot2c_f32_bf16 v50, v168, v43
    v_dot2c_f32_bf16 v51, v173, v43
    v_dot2c_f32_bf16 v52, v169, v43
    v_dot2c_f32_bf16 v53, v174, v43
    v_dot2c_f32_bf16 v54, v170, v43
    v_dot2c_f32_bf16 v55, v175, v43
    v_permlane32_swap_b32 v48, v52
    v_permlane32_swap_b32 v49, v53
    v_permlane32_swap_b32 v50, v54
    v_permlane32_swap_b32 v51, v55
    v_add_f32 v48, v48, v52
    v_add_f32 v49, v49, v53
    v_add_f32 v50, v50, v54
    v_add_f32 v51, v51, v55
    v_mov_b32 v52, v48
    v_mov_b32 v53, v49
    v_mov_b32 v54, v50
    v_mov_b32 v55, v51
    v_permlane16_swap_b32 v52, v48
    v_permlane16_swap_b32 v53, v49
    v_permlane16_swap_b32 v54, v50
    v_permlane16_swap_b32 v55, v51
    v_add_f32 v48, v48, v52
    v_add_f32 v49, v49, v53
    v_add_f32 v50, v50, v54
    v_add_f32 v51, v51, v55
    s_cmp_eq_u32 s69, 0
    s_cbranch_scc0 L_ffn_nores
    v_add_f32 v48, v48, v212
    v_add_f32 v49, v49, v213
    v_add_f32 v50, v50, v214
    v_add_f32 v51, v51, v215
L_ffn_nores:
    v_bfi_b32 v48, s68, v23, v48
    v_bfi_b32 v49, s68, v23, v49
    v_bfi_b32 v50, s68, v23, v50
    v_bfi_b32 v51, s68, v23, v51
    s_and_b32 exec_lo, s90, 0xffff
    s_and_b32 exec_hi, s91, 0xffff
    s_cmp_eq_u32 s90, 0
    s_cbranch_scc1 L_nost_16
    buffer_store_dwordx4 v[48:51], v77, s[16:19], s46 offen sc1
L_nost_16:
    s_mov_b64 exec, s[90:91]
    s_branch L_exit
L_role_red:
    s_cmp_eq_u32 s3, 0
    s_cselect_b32 s28, 1, 0
    s_cmp_eq_u32 s90, 0
    s_cselect_b32 s28, 1, s28
    s_cmp_eq_u32 s28, 0
    s_cbranch_scc1 L_exit
    s_sub_u32 s30, s2, 128
    s_and_b32 s28, s30, 7
    s_lshr_b32 s29, s30, 4
    s_lshl_b32 s29, s29, 3
    s_add_u32 s28, s28, s29
    s_lshl_b32 s28, s28, 1
    s_lshr_b32 s30, s30, 3
    s_and_b32 s30, s30, 1
    s_add_u32 s30, s30, s28
    v_lshrrev_b32 v56, 2, v0
    v_lshlrev_b32 v64, 11, v56
    v_and_b32 v57, 3, v0
    v_lshl_add_u32 v64, v57, 4, v64
    s_lshl_b32 s33, s30, 6
    s_add_u32 s33, s33, 917504
    v_mov_b32 v192, v23
    v_mov_b32 v193, v23
    v_mov_b32 v194, v23
    v_mov_b32 v195, v23
    s_mov_b32 s20, s54
    s_and_b32 s21, s55, 0xffff
    s_mov_b32 s22, 0x400
    s_mov_b32 s23, 0x20000
    v_lshlrev_b32 v65, 3, v0
    s_lshl_b32 s34, s30, 5
    v_mov_b32 v66, s7
    v_mov_b32 v67, 0
    s_cmp_eq_u32 s90, 0
    s_cbranch_scc1 L_nost_17
    buffer_load_dword v77, v67, s[20:23], 0 offen
L_nost_17:
    s_mov_b32 s62, 200000
L_poll_D:
    s_cmp_eq_u32 s90, 0
    s_cbranch_scc1 L_dryld_18
    s_add_u32 s35, s33, 0
    buffer_load_dwordx4 v[180:183], v64, s[16:19], s35 offen sc1
    s_add_u32 s35, s33, 32768
    buffer_load_dwordx4 v[184:187], v64, s[16:19], s35 offen sc1
    s_add_u32 s35, s33, 65536
    buffer_load_dwordx4 v[188:191], v64, s[16:19], s35 offen sc1
    s_add_u32 s35, s33, 98304
    s_mov_b32 exec_hi, 0
    buffer_load_dwordx4 v[192:195], v64, s[16:19], s35 offen sc1
    s_mov_b64 exec, -1
L_dryld_18:
    s_waitcnt vmcnt(3)
    v_xor_b32 v79, v180, v23
    v_bitop3_b32 v79, v181, v23, v79 bitop3:0xBE
    v_bitop3_b32 v79, v182, v23, v79 bitop3:0xBE
    v_bitop3_b32 v79, v183, v23, v79 bitop3:0xBE
    s_waitcnt vmcnt(2)
    v_bitop3_b32 v79, v184, v23, v79 bitop3:0xBE
    v_bitop3_b32 v79, v185, v23, v79 bitop3:0xBE
    v_bitop3_b32 v79, v186, v23, v79 bitop3:0xBE
    v_bitop3_b32 v79, v187, v23, v79 bitop3:0xBE
    v_add_f32 v24, v180, v184
    v_add_f32 v25, v181, v185
    v_add_f32 v26, v182, v186
    v_add_f32 v27, v183, v187
    s_waitcnt vmcnt(1)
    v_bitop3_b32 v79, v188, v23, v79 bitop3:0xBE
    v_bitop3_b32 v79, v189, v23, v79 bitop3:0xBE
    v_bitop3_b32 v79, v190, v23, v79 bitop3:0xBE
    v_bitop3_b32 v79, v191, v23, v79 bitop3:0xBE
    v_add_f32 v24, v24, v188
    v_add_f32 v25, v25, v189
    v_add_f32 v26, v26, v190
    v_add_f32 v27, v27, v191
    s_waitcnt vmcnt(0)
    v_bitop3_b32 v79, v192, v23, v79 bitop3:0xBE
    v_bitop3_b32 v79, v193, v23, v79 bitop3:0xBE
    v_bitop3_b32 v79, v194, v23, v79 bitop3:0xBE
    v_bitop3_b32 v79, v195, v23, v79 bitop3:0xBE
    v_add_f32 v24, v24, v192
    v_add_f32 v25, v25, v193
    v_add_f32 v26, v26, v194
    v_add_f32 v27, v27, v195
    v_and_b32 v79, 0xfff, v79
    v_cmp_ne_u32 vcc, 0, v79
    s_cbranch_vccz L_pollok_D
L_pollretry_D:
    s_sub_u32 s62, s62, 1
    s_cmp_eq_u32 s62, 0
    s_cbranch_scc0 L_poll_D
L_pollok_D:
    v_add_f32_dpp v24, v24, v24 row_ror:4 row_mask:0xf bank_mask:0xf
    v_add_f32_dpp v25, v25, v25 row_ror:4 row_mask:0xf bank_mask:0xf
    v_add_f32_dpp v26, v26, v26 row_ror:4 row_mask:0xf bank_mask:0xf
    v_add_f32_dpp v27, v27, v27 row_ror:4 row_mask:0xf bank_mask:0xf
    v_add_f32_dpp v24, v24, v24 row_ror:8 row_mask:0xf bank_mask:0xf
    v_add_f32_dpp v25, v25, v25 row_ror:8 row_mask:0xf bank_mask:0xf
    v_add_f32_dpp v26, v26, v26 row_ror:8 row_mask:0xf bank_mask:0xf
    v_add_f32_dpp v27, v27, v27 row_ror:8 row_mask:0xf bank_mask:0xf
    v_mov_b32 v28, v24
    v_mov_b32 v29, v25
    v_mov_b32 v30, v26
    v_mov_b32 v31, v27
    v_permlane16_swap_b32 v28, v24
    v_permlane16_swap_b32 v29, v25
    v_permlane16_swap_b32 v30, v26
    v_permlane16_swap_b32 v31, v27
    v_add_f32 v24, v24, v28
    v_add_f32 v25, v25, v29
    v_add_f32 v26, v26, v30
    v_add_f32 v27, v27, v31
    v_mov_b32 v28, v24
    v_mov_b32 v29, v25
    v_mov_b32 v30, v26
    v_mov_b32 v31, v27
    v_permlane32_swap_b32 v28, v24
    v_permlane32_swap_b32 v29, v25
    v_permlane32_swap_b32 v30, v26
    v_permlane32_swap_b32 v31, v27
    v_add_f32 v24, v24, v28
    v_add_f32 v25, v25, v29
    v_add_f32 v26, v26, v30
    v_add_f32 v27, v27, v31
    v_cvt_pk_bf16_f32 v32, v24, v25
    v_cvt_pk_bf16_f32 v33, v26, v27
    s_and_b32 exec_lo, s90, 0xf
    s_and_b32 exec_hi, s91, 0x0
    s_cmp_eq_u32 s90, 0
    s_cbranch_scc1 L_nost_19
    buffer_store_dwordx2 v[32:33], v65, s[20:23], s34 offen
L_nost_19:
    s_cmp_eq_u32 s30, 0
    s_cbranch_scc0 L_red_nogen_20
    s_and_b32 exec_lo, s90, 0x1
    s_and_b32 exec_hi, s91, 0x0
    s_cmp_eq_u32 s90, 0
    s_cbranch_scc1 L_nost_21
    buffer_store_dword v66, v67, s[16:19], 0 offen sc1
L_nost_21:
L_red_nogen_20:
    s_mov_b64 exec, s[90:91]
    s_branch L_exit
L_exit:
    s_cmp_eq_u32 s90, 0
    s_cbranch_scc1 L_dryback
L_end:
    s_endpgm
.section .rodata,"a"
.p2align 6
.amdhsa_kernel sequential_preLN__gqa_block_cached__glu_gated_geglu__decode_kernel
  .amdhsa_next_free_vgpr 448
  .amdhsa_next_free_sgpr 102
  .amdhsa_accum_offset 256
  .amdhsa_group_segment_fixed_size 0
  .amdhsa_kernarg_size 96
  .amdhsa_user_sgpr_count 2
  .amdhsa_user_sgpr_kernarg_segment_ptr 1
  .amdhsa_system_sgpr_workgroup_id_x 1
.end_amdhsa_kernel
```
